```python
import torch

def _softmax(x, axis=-1):
    return torch.softmax(x, dim=axis)
def _gelu(x):
    return torch.nn.functional.gelu(x, approximate="tanh")
def _silu(x):
    return torch.nn.functional.silu(x)
def _sigmoid(x):
    return torch.sigmoid(x)
def _layernorm(x, axis=-1, eps=1e-5):
    m = x.mean(dim=axis, keepdim=True)
    v = x.var(dim=axis, keepdim=True, unbiased=False)
    return (x - m) / torch.sqrt(v + eps)
def _scatter_add(tgt, idx, src, axis=0):
    return tgt.clone().index_add_(axis, idx, src)
def _segment_sum(src, seg, n):
    out = torch.zeros((n,) + src.shape[1:], dtype=src.dtype)
    return out.index_add_(0, seg, src)
def _pad(x, pw):
    flat = tuple(v for pair in reversed(pw) for v in pair)
    return torch.nn.functional.pad(x, flat)

kernel_name = 'recurrent_scan__spectral_fnet__geglu_ffn__prompt'

def setup_inputs():

    _w = (lambda a: (lambda t: t.to(torch.bfloat16) if t.is_floating_point() else t)(torch.as_tensor(a)))
    def _A_setup():
        B, S, D = 1, 2048, 448
        ns = torch.arange(S)[:, None] * torch.arange(S)[None, :]
        nd = torch.arange(D)[:, None] * torch.arange(D)[None, :]
        Ws_re = torch.cos(-2.0 * torch.pi * ns / S).to(float)
        Ws_im = torch.sin(-2.0 * torch.pi * ns / S).to(float)
        Wd_re = torch.cos(-2.0 * torch.pi * nd / D).to(float)
        Wd_im = torch.sin(-2.0 * torch.pi * nd / D).to(float)
        return {
            "x": _w((lambda *s: torch.randn(*s, dtype=torch.bfloat16) * 0.05)(B, S, D)),
            "dft_seq_re": _w(Ws_re),
            "dft_seq_im": _w(Ws_im),
            "dft_hid_re": _w(Wd_re),
            "dft_hid_im": _w(Wd_im),
        }
    _A_in = _A_setup()

    def _B_setup():
        B, S, D, F = 1, 2048, 448, 1792
        return {
            "x": _w((lambda *s: torch.randn(*s, dtype=torch.bfloat16) * 0.05)(B, S, D)),
            "w_gate": _w((lambda *s: torch.randn(*s, dtype=torch.bfloat16) * 0.05)(D, F)),
            "w_up": _w((lambda *s: torch.randn(*s, dtype=torch.bfloat16) * 0.05)(D, F)),
            "w_down": _w((lambda *s: torch.randn(*s, dtype=torch.bfloat16) * 0.05)(F, D)),
        }
    _B_in = _B_setup()

    return {
        "A_x": _A_in["x"],
        "A_dft_seq_re": _A_in["dft_seq_re"],
        "A_dft_seq_im": _A_in["dft_seq_im"],
        "A_dft_hid_re": _A_in["dft_hid_re"],
        "A_dft_hid_im": _A_in["dft_hid_im"],
        "B_x": _B_in["x"],
        "B_w_gate": _B_in["w_gate"],
        "B_w_up": _B_in["w_up"],
        "B_w_down": _B_in["w_down"],
    }

def reference(A_x, A_dft_seq_re, A_dft_seq_im, A_dft_hid_re, A_dft_hid_im, B_x, B_w_gate, B_w_up, B_w_down):
    def _A_ref(x, dft_seq_re, dft_seq_im, dft_hid_re, dft_hid_im):
        a = torch.einsum("bsd,ed->bse", x, dft_hid_re)
        b = torch.einsum("bsd,ed->bse", x, dft_hid_im)
        y = torch.einsum("ts,bse->bte", dft_seq_re, a) - torch.einsum("ts,bse->bte", dft_seq_im, b)
        return y

    def _B_ref(x, w_gate, w_up, w_down):
        return (_gelu(x @ w_gate) * (x @ w_up)) @ w_down

    x = A_x
    xn = _layernorm(x, axis=-1)
    s = _A_ref(xn, A_dft_seq_re, A_dft_seq_im, A_dft_hid_re, A_dft_hid_im)
    g = _silu(_B_ref(xn, B_w_gate, B_w_up, B_w_down))
    return x + s * g
```

```asm
; @launch grid=(256,1,1) block=(512,1,1) lds=163840
.amdgcn_target "amdgcn-amd-amdhsa--gfx950"
.text
.globl recurrent_scan__spectral_fnet__geglu_ffn__prompt_kernel
.p2align 8
.type recurrent_scan__spectral_fnet__geglu_ffn__prompt_kernel,@function
recurrent_scan__spectral_fnet__geglu_ffn__prompt_kernel:
    s_cmp_ge_u32 s2, 0x100
    s_cbranch_scc1 L_end
    s_load_dwordx16 s[16:31], s[0:1], 0
    s_load_dwordx8 s[32:39], s[0:1], 64
    s_memrealtime s[74:75]
    s_getpc_b64 s[68:69]
L_pc:
    v_lshlrev_b32 v20, 2, v0
    global_load_dword v63, v20, s[68:69]
    v_lshrrev_b32 v22, 6, v0
    v_lshrrev_b32 v20, 3, v0
    v_readfirstlane_b32 s3, v22
    s_lshr_b32 s7, s2, 3
    s_bfe_u32 s14, s2, 0x20001
    v_lshrrev_b32 v23, 4, v0
    s_mul_i32 s15, s14, 28
    v_and_b32 v21, 31, v20
    s_add_u32 s15, s15, s7
    v_xor_b32 v23, v23, v0
    s_and_b32 s4, s15, 7
    v_mul_u32_u24 v2, 57344, v21
    s_lshl_b32 s79, s4, 2
    v_and_b32 v23, 7, v23
    s_lshr_b32 s79, 0x03625140, s79
    v_lshlrev_b32 v14, 4, v23
    s_and_b32 s79, s79, 15
    s_and_b32 s13, s2, 1
    v_add_u32 v2, v2, v14
    s_lshl3_add_u32 s4, s13, s4
    s_lshr_b32 s6, s3, 2
    s_lshl_b32 s13, s6, 5
    s_xor_b32 s8, s4, s13
    s_mul_i32 s8, s8, 7
    s_add_u32 s8, s8, s79
    s_lshl_b32 s8, s8, 7
    s_sub_u32 s77, 64, s4
    s_cmp_eq_u32 s4, 0
    s_cselect_b32 s77, 16, s77
    s_xor_b32 s0, s77, s13
    s_mul_i32 s0, s0, 7
    s_add_u32 s0, s0, s79
    s_lshl_b32 s0, s0, 7
    s_lshl_b32 s1, s3, 10
    v_and_b32 v0, 63, v0
    s_mov_b32 s42, 1835008
    s_mov_b32 s43, 0x20000
    s_waitcnt lgkmcnt(0)
    s_mov_b32 s40, s16
    s_and_b32 s41, s17, 0xffff
    s_add_u32 m0, s1, 98304
    s_nop 0
    buffer_load_dwordx4 v2, s[40:43], s8 offen lds
    s_add_u32 m0, s1, 106496
    s_nop 0
    buffer_load_dwordx4 v2, s[40:43], s0 offen lds
    v_lshrrev_b32 v22, 3, v0
    s_lshr_b32 s5, s15, 3
    s_cmp_ge_u32 s7, 28
    s_cbranch_scc1 L_dft
    s_bitcmp1_b32 s3, 0
    s_cselect_b32 s44, s30, s28
    s_cselect_b32 s45, s31, s29
    s_and_b32 s45, s45, 0xffff
    s_mov_b32 s46, 1605632
    s_mov_b32 s47, 0x20000
    v_mul_u32_u24 v3, 3584, v22
    s_lshl3_add_u32 s9, s79, s6
    v_bfe_u32 v21, v0, 0, 3
    s_mul_i32 s9, s9, 224
    v_bfe_u32 v20, v0, 4, 1
    s_lshl1_add_u32 s9, s5, s9
    s_and_b32 s13, s3, 1
    s_bfe_u32 s7, s3, 0x10001
    v_lshl_or_b32 v20, s13, 1, v20
    s_add_u32 s9, s9, s7
    v_lshlrev_b32 v20, 1, v20
    s_lshl_b32 s9, s9, 7
    v_xor_b32 v21, v21, v20
    s_mul_i32 s11, s7, 48
    v_lshl_add_u32 v3, v21, 4, v3
    s_lshl1_add_u32 s11, s6, s11
    s_add_u32 s11, s11, s13
    s_lshl_b32 s11, s11, 10
    s_add_u32 m0, s11, 0
    s_nop 0
    buffer_load_dwordx4 v3, s[44:47], s9 offen lds
    v_add_u32 v4, 57344, v3
    s_add_u32 s10, s9, 114688
    s_barrier
    s_add_u32 m0, s11, 4096
    s_nop 0
    buffer_load_dwordx4 v4, s[44:47], s9 offen lds
    s_add_u32 m0, s11, 8192
    s_nop 0
    buffer_load_dwordx4 v3, s[44:47], s10 offen lds
    s_add_u32 m0, s11, 12288
    s_nop 0
    buffer_load_dwordx4 v4, s[44:47], s10 offen lds
    s_add_u32 s79, s79, 1
    s_cmp_eq_u32 s79, 7
    s_cselect_b32 s15, -6, 1
    s_mul_i32 s14, s15, 128
    s_add_u32 s8, s8, s14
    s_add_u32 s0, s0, s14
    s_mul_i32 s14, s15, 229376
    s_add_u32 s9, s9, s14
    s_add_u32 s10, s10, s14
    s_lshl_b32 s12, s3, 11
    v_and_b32 v15, 31, v0
    v_lshrrev_b32 v22, 5, v0
    v_bfe_u32 v23, v15, 1, 3
    v_xor_b32 v23, v23, v22
    v_lshlrev_b32 v23, 4, v23
    v_lshl_or_b32 v23, v15, 7, v23
    s_and_b32 s6, s3, 1
    s_lshl_b32 s7, s6, 13
    s_add_u32 s7, s7, 98304
    v_add_u32 v6, s7, v23
    v_xor_b32 v7, 32, v6
    v_xor_b32 v8, 64, v6
    v_xor_b32 v9, 96, v6
    s_lshr_b32 s7, s3, 2
    s_mul_i32 s7, s7, 49152
    s_and_b32 s13, s3, 3
    v_lshrrev_b32 v20, 4, v0
    v_lshlrev_b32 v22, 10, v20
    v_bfe_u32 v21, v0, 3, 1
    v_lshl_or_b32 v22, v21, 8, v22
    v_lshl_or_b32 v22, v21, 5, v22
    v_bfe_u32 v21, v0, 2, 1
    v_lshl_or_b32 v22, v21, 7, v22
    v_and_b32 v21, 1, v20
    v_lshl_or_b32 v22, v21, 6, v22
    v_and_b32 v21, 1, v0
    v_lshl_or_b32 v22, v21, 4, v22
    v_bfe_u32 v21, v0, 1, 1
    v_lshl_or_b32 v22, v21, 3, v22
    s_lshl_b32 s13, s13, 5
    v_xor_b32 v10, s13, v22
    v_add_u32 v10, s7, v10
    v_xor_b32 v11, 32, v10
    v_mov_b32 v18, 0
    s_barrier
    s_mov_b32 s64, s36
    s_and_b32 s65, s37, 0xffff
    s_mov_b32 s66, 256
    s_mov_b32 s67, 0x20000
    s_or_b32 s74, s74, 1
    s_lshr_b32 s6, s2, 3
    s_or_b32 s6, s6, s3
    s_lshl_b32 s6, s6, 12
    v_mov_b32 v60, s74
    v_mov_b32 v61, 0
    v_lshlrev_b32 v62, 24, v0
    buffer_atomic_cmpswap v[60:61], v62, s[64:67], s6 offen sc1
    s_mov_b32 s74, 0x3f803f80
    s_add_u32 m0, s1, 114688
    s_nop 0
    buffer_load_dwordx4 v2, s[40:43], s8 offen lds
    s_add_u32 m0, s1, 122880
    s_nop 0
    buffer_load_dwordx4 v2, s[40:43], s0 offen lds
    v_lshlrev_b32 v1, 4, v0
    s_waitcnt vmcnt(6)
    s_barrier
    ds_read_b64_tr_b16 v[144:145], v10 offset:0
    ds_read_b64_tr_b16 v[146:147], v10 offset:512
    ds_read_b128 v[128:131], v6 offset:0
    ds_read_b64_tr_b16 v[148:149], v11 offset:0
    ds_read_b64_tr_b16 v[150:151], v11 offset:512
    ds_read_b128 v[132:135], v6 offset:4096
    s_waitcnt lgkmcnt(0)
    v_mfma_f32_32x32x16_bf16 v[64:79], v[144:147], v[128:131], 0
    s_add_u32 m0, s11, 16384
    s_nop 0
    buffer_load_dwordx4 v3, s[44:47], s9 offen lds
    s_waitcnt vmcnt(6)
    s_barrier
    v_mfma_f32_32x32x16_bf16 v[96:111], v[148:151], v[128:131], 0
    ds_read_b64_tr_b16 v[152:153], v10 offset:4096
    ds_read_b64_tr_b16 v[154:155], v10 offset:4608
    s_add_u32 m0, s11, 20480
    s_nop 0
    buffer_load_dwordx4 v4, s[44:47], s9 offen lds
    v_mfma_f32_32x32x16_bf16 v[112:127], v[148:151], v[132:135], 0
    ds_read_b128 v[136:139], v7 offset:0
    ds_read_b64_tr_b16 v[156:157], v11 offset:4096
    s_add_u32 m0, s11, 24576
    s_nop 0
    buffer_load_dwordx4 v3, s[44:47], s10 offen lds
    v_mfma_f32_32x32x16_bf16 v[80:95], v[144:147], v[132:135], 0
    ds_read_b64_tr_b16 v[158:159], v11 offset:4608
    ds_read_b128 v[140:143], v7 offset:4096
    v_dot2c_f32_bf16 v18, s74, v144
    v_dot2c_f32_bf16 v18, s74, v145
    v_dot2c_f32_bf16 v18, s74, v146
    v_dot2c_f32_bf16 v18, s74, v147
    s_add_u32 m0, s11, 28672
    s_nop 0
    buffer_load_dwordx4 v4, s[44:47], s10 offen lds
    s_add_u32 s79, s79, 1
    s_cmp_eq_u32 s79, 7
    s_cselect_b32 s15, -6, 1
    s_mul_i32 s14, s15, 128
    s_add_u32 s8, s8, s14
    s_add_u32 s0, s0, s14
    s_mul_i32 s14, s15, 229376
    s_add_u32 s9, s9, s14
    s_add_u32 s10, s10, s14
    s_waitcnt lgkmcnt(0)
    v_mfma_f32_32x32x16_bf16 v[64:79], v[152:155], v[136:139], v[64:79]
    v_lshlrev_b32 v1, 4, v0
    s_lshl3_add_u32 s76, s5, s3
    s_and_b32 s13, s76, 31
    s_lshl_b32 s13, s13, 6
    s_lshr_b32 s14, s76, 5
    s_bitcmp1_b32 s14, 1
    s_cselect_b32 s6, s77, s4
    s_and_b32 s7, s14, 1
    s_lshl_b32 s7, s7, 5
    s_xor_b32 s6, s6, s7
    s_add_u32 s13, s13, s6
    s_mul_i32 s13, s13, 896
    v_mov_b32 v25, 2130706432
    v_cmp_gt_u32 vcc, 56, v0
    s_nop 1
    v_cndmask_b32 v25, v25, v1, vcc
    buffer_load_dwordx4 v[32:35], v25, s[40:43], s13 offen
    s_waitcnt vmcnt(9)
    s_barrier
    v_mfma_f32_32x32x16_bf16 v[96:111], v[156:159], v[136:139], v[96:111]
    ds_read_b64_tr_b16 v[144:145], v10 offset:8192
    ds_read_b64_tr_b16 v[146:147], v10 offset:8704
    v_mfma_f32_32x32x16_bf16 v[112:127], v[156:159], v[140:143], v[112:127]
    ds_read_b128 v[128:131], v8 offset:0
    ds_read_b64_tr_b16 v[148:149], v11 offset:8192
    s_lshr_b32 s6, s2, 3
    s_lshl3_add_u32 s6, s6, s3
    s_lshl_b32 s6, s6, 7
    s_min_u32 s6, s6, L_end-L_pc
    v_mov_b32 v20, s6
    global_load_dword v186, v20, s[68:69]
    v_mfma_f32_32x32x16_bf16 v[80:95], v[152:155], v[140:143], v[80:95]
    ds_read_b64_tr_b16 v[150:151], v11 offset:8704
    ds_read_b128 v[132:135], v8 offset:4096
    v_dot2c_f32_bf16 v18, s74, v152
    v_dot2c_f32_bf16 v18, s74, v153
    v_dot2c_f32_bf16 v18, s74, v154
    v_dot2c_f32_bf16 v18, s74, v155
    s_add_u32 m0, s1, 131072
    s_nop 0
    buffer_load_dwordx4 v2, s[40:43], s8 offen lds
    s_waitcnt lgkmcnt(0)
    v_mfma_f32_32x32x16_bf16 v[64:79], v[144:147], v[128:131], v[64:79]
    s_mov_b32 s56, s38
    s_and_b32 s57, s39, 0xffff
    s_mov_b32 s58, 10059776
    s_mov_b32 s59, 0x20000
    s_waitcnt vmcnt(10)
    s_barrier
    v_mfma_f32_32x32x16_bf16 v[96:111], v[148:151], v[128:131], v[96:111]
    ds_read_b64_tr_b16 v[152:153], v10 offset:12288
    ds_read_b64_tr_b16 v[154:155], v10 offset:12800
    s_add_u32 m0, s1, 139264
    s_nop 0
    buffer_load_dwordx4 v2, s[40:43], s0 offen lds
    s_lshl_b32 s6, s4, 7
    s_add_u32 s76, s76, s6
    s_lshl_b32 s76, s76, 3
    s_add_u32 s76, s76, 9437184
    v_mfma_f32_32x32x16_bf16 v[112:127], v[148:151], v[132:135], v[112:127]
    ds_read_b128 v[136:139], v9 offset:0
    ds_read_b64_tr_b16 v[156:157], v11 offset:12288
    s_lshl_b32 s72, s5, 4
    s_add_u32 s72, s72, s4
    s_lshl_b32 s73, s72, 3
    s_add_u32 s73, s73, s3
    v_mfma_f32_32x32x16_bf16 v[80:95], v[144:147], v[132:135], v[80:95]
    ds_read_b64_tr_b16 v[158:159], v11 offset:12800
    ds_read_b128 v[140:143], v9 offset:4096
    v_dot2c_f32_bf16 v18, s74, v144
    v_dot2c_f32_bf16 v18, s74, v145
    v_dot2c_f32_bf16 v18, s74, v146
    v_dot2c_f32_bf16 v18, s74, v147
    s_add_u32 m0, s11, 32768
    s_nop 0
    buffer_load_dwordx4 v3, s[44:47], s9 offen lds
    s_lshl_b32 s73, s73, 8
    s_add_u32 s73, s73, 9502720
    s_and_b32 s6, s72, 0xf8
    s_lshl_b32 s7, s6, 11
    s_waitcnt lgkmcnt(0)
    v_mfma_f32_32x32x16_bf16 v[64:79], v[152:155], v[136:139], v[64:79]
    s_add_u32 s7, s7, 9502720
    s_add_u32 s77, s7, s12
    s_lshl_b32 s13, s4, 10
    s_add_u32 s13, s13, 9437184
    s_waitcnt vmcnt(5)
    s_barrier
    v_mfma_f32_32x32x16_bf16 v[96:111], v[156:159], v[136:139], v[96:111]
    ds_read_b64_tr_b16 v[144:145], v10 offset:16384
    ds_read_b64_tr_b16 v[146:147], v10 offset:16896
    s_cmp_eq_u32 s3, 7
    s_cselect_b32 s77, s13, s77
    v_lshrrev_b32 v20, 5, v0
    v_xor_b32 v20, s3, v20
    v_and_b32 v21, 31, v0
    v_mfma_f32_32x32x16_bf16 v[112:127], v[156:159], v[140:143], v[112:127]
    ds_read_b128 v[128:131], v6 offset:16384
    ds_read_b64_tr_b16 v[148:149], v11 offset:16384
    s_add_u32 m0, s11, 36864
    s_nop 0
    buffer_load_dwordx4 v4, s[44:47], s9 offen lds
    v_lshlrev_b32 v21, 3, v21
    v_lshl_add_u32 v20, v20, 8, v21
    v_add_u32 v43, s7, v20
    v_add_u32 v13, 147456, v20
    v_mfma_f32_32x32x16_bf16 v[80:95], v[152:155], v[140:143], v[80:95]
    ds_read_b64_tr_b16 v[150:151], v11 offset:16896
    ds_read_b128 v[132:135], v6 offset:20480
    v_dot2c_f32_bf16 v18, s74, v152
    v_dot2c_f32_bf16 v18, s74, v153
    v_dot2c_f32_bf16 v18, s74, v154
    v_dot2c_f32_bf16 v18, s74, v155
    s_add_u32 m0, s11, 40960
    s_nop 0
    buffer_load_dwordx4 v3, s[44:47], s10 offen lds
    s_and_b32 s6, s3, 1
    s_lshl_b32 s6, s6, 9
    v_lshl_add_u32 v20, v15, 3, s6
    v_add_u32 v42, s13, v20
    s_waitcnt lgkmcnt(0)
    v_mfma_f32_32x32x16_bf16 v[64:79], v[144:147], v[128:131], v[64:79]
    ds_read_b64_tr_b16 v[152:153], v10 offset:20480
    ds_read_b64_tr_b16 v[154:155], v10 offset:20992
    v_add_u32 v60, 161792, v20
    s_lshl_b32 s72, s4, 4
    s_add_u32 s72, s72, s5
    s_lshl_b32 s72, s72, 7
    v_mfma_f32_32x32x16_bf16 v[96:111], v[148:151], v[128:131], v[96:111]
    ds_read_b128 v[136:139], v7 offset:16384
    ds_read_b64_tr_b16 v[156:157], v11 offset:20480
    s_add_u32 m0, s11, 45056
    s_nop 0
    buffer_load_dwordx4 v4, s[44:47], s10 offen lds
    s_add_u32 s79, s79, 1
    s_cmp_eq_u32 s79, 7
    s_cselect_b32 s15, -6, 1
    s_mul_i32 s14, s15, 128
    s_add_u32 s8, s8, s14
    s_add_u32 s0, s0, s14
    s_mul_i32 s14, s15, 229376
    s_add_u32 s9, s9, s14
    s_add_u32 s10, s10, s14
    s_lshl_b32 s6, s3, 2
    s_add_u32 s72, s72, s6
    s_add_u32 s72, s72, 10027008
    buffer_load_dword v57, v61, s[64:67], 0 offen sc1
    v_mfma_f32_32x32x16_bf16 v[112:127], v[148:151], v[132:135], v[112:127]
    ds_read_b64_tr_b16 v[158:159], v11 offset:20992
    ds_read_b128 v[140:143], v7 offset:20480
    s_waitcnt vmcnt(8)
    v_mov_b32 v28, 0
    v_mov_b32 v29, 0
    v_dot2c_f32_bf16 v28, s74, v32
    v_dot2c_f32_bf16 v29, v32, v32
    v_dot2c_f32_bf16 v28, s74, v33
    v_dot2c_f32_bf16 v29, v33, v33
    v_dot2c_f32_bf16 v28, s74, v34
    v_dot2c_f32_bf16 v29, v34, v34
    v_dot2c_f32_bf16 v28, s74, v35
    v_dot2c_f32_bf16 v29, v35, v35
    s_nop 2
    v_permlane32_swap_b32 v28, v29
    v_add_f32 v28, v28, v29
    v_mov_b32 v30, v28
    v_mfma_f32_32x32x16_bf16 v[80:95], v[144:147], v[132:135], v[80:95]
    s_add_u32 m0, s1, 98304
    s_nop 0
    buffer_load_dwordx4 v2, s[40:43], s8 offen lds
    v_permlane16_swap_b32 v28, v30
    v_add_f32 v28, v28, v30
    s_nop 1
    v_add_f32_dpp v28, v28, v28 row_ror:8 row_mask:0xf bank_mask:0xf
    s_nop 1
    v_add_f32_dpp v28, v28, v28 row_ror:4 row_mask:0xf bank_mask:0xf
    s_waitcnt lgkmcnt(0)
    v_mfma_f32_32x32x16_bf16 v[64:79], v[152:155], v[136:139], v[64:79]
    ds_read_b64_tr_b16 v[144:145], v10 offset:24576
    ds_read_b64_tr_b16 v[146:147], v10 offset:25088
    v_add_f32_dpp v28, v28, v28 row_ror:2 row_mask:0xf bank_mask:0xf
    s_nop 1
    v_add_f32_dpp v28, v28, v28 row_ror:1 row_mask:0xf bank_mask:0xf
    v_mul_f32 v28, 0x3b124925, v28
    v_mov_b32 v29, v28
    v_mfma_f32_32x32x16_bf16 v[96:111], v[156:159], v[136:139], v[96:111]
    ds_read_b128 v[128:131], v8 offset:16384
    ds_read_b64_tr_b16 v[148:149], v11 offset:24576
    s_add_u32 m0, s1, 106496
    s_nop 0
    buffer_load_dwordx4 v2, s[40:43], s0 offen lds
    v_permlane32_swap_b32 v28, v29
    v_fma_f32 v29, -v28, v28, v29
    v_max_f32 v29, 0, v29
    v_cvt_pk_bf16_f32 v29, v29, v29
    v_mfma_f32_32x32x16_bf16 v[112:127], v[156:159], v[140:143], v[112:127]
    ds_read_b64_tr_b16 v[150:151], v11 offset:25088
    ds_read_b128 v[132:135], v8 offset:20480
    v_lshlrev_b32 v29, 16, v29
    v_add_f32 v29, 0x3727c5ac, v29
    v_cvt_pk_bf16_f32 v29, v29, v29
    v_lshlrev_b32 v29, 16, v29
    v_mfma_f32_32x32x16_bf16 v[80:95], v[152:155], v[140:143], v[80:95]
    s_add_u32 m0, s11, 0
    s_nop 0
    buffer_load_dwordx4 v3, s[44:47], s9 offen lds
    v_sqrt_f32 v29, v29
    s_nop 0
    v_cvt_pk_bf16_f32 v56, v28, v29
    s_waitcnt vmcnt(3)
    v_cmp_eq_u32 vcc, 0, v57
    s_nop 1
    s_cbranch_vccz L_ok0
    s_mov_b32 s75, 0x10000
L_spin0:
    s_sleep 2
    buffer_load_dword v57, v61, s[64:67], 0 offen sc1
    s_waitcnt vmcnt(0)
    v_cmp_eq_u32 vcc, 0, v57
    s_nop 1
    s_cbranch_vccz L_ok0
    s_sub_u32 s75, s75, 1
    s_cmp_lg_u32 s75, 0
    s_cbranch_scc1 L_spin0
L_ok0:
    v_readfirstlane_b32 s78, v57
    s_waitcnt lgkmcnt(0)
    v_mfma_f32_32x32x16_bf16 v[64:79], v[144:147], v[128:131], v[64:79]
    ds_read_b64_tr_b16 v[152:153], v10 offset:28672
    ds_read_b64_tr_b16 v[154:155], v10 offset:29184
    buffer_store_dwordx2 v[56:57], v62, s[56:59], s76 offen sc1
    v_mov_b32 v58, v18
    v_mov_b32 v59, v57
    v_and_b32 v28, 31, v0
    v_mfma_f32_32x32x16_bf16 v[96:111], v[148:151], v[128:131], v[96:111]
    ds_read_b128 v[136:139], v9 offset:16384
    ds_read_b64_tr_b16 v[156:157], v11 offset:28672
    s_add_u32 m0, s11, 4096
    s_nop 0
    buffer_load_dwordx4 v4, s[44:47], s9 offen lds
    v_permlane32_swap_b32 v18, v58
    v_lshlrev_b32 v28, 3, v28
    v_add_f32 v58, v18, v58
    buffer_store_dwordx2 v[58:59], v28, s[56:59], s73 offen sc1
    v_mfma_f32_32x32x16_bf16 v[112:127], v[148:151], v[132:135], v[112:127]
    ds_read_b64_tr_b16 v[158:159], v11 offset:29184
    ds_read_b128 v[140:143], v9 offset:20480
    s_lshr_b32 s7, s2, 3
    s_mul_i32 s70, s7, 37
    s_lshr_b32 s70, s70, 8
    s_mul_i32 s71, s70, 7
    v_mfma_f32_32x32x16_bf16 v[80:95], v[144:147], v[132:135], v[80:95]
    s_add_u32 m0, s11, 8192
    s_nop 0
    buffer_load_dwordx4 v3, s[44:47], s10 offen lds
    s_sub_u32 s71, s7, s71
    s_and_b32 s6, s2, 1
    s_lshl4_add_u32 s70, s6, s70
    s_and_b32 s6, s2, 6
    s_waitcnt lgkmcnt(0)
    v_mfma_f32_32x32x16_bf16 v[64:79], v[152:155], v[136:139], v[64:79]
    s_lshl1_add_u32 s70, s6, s70
    s_lshr_b32 s6, s70, 1
    s_sub_u32 s7, 64, s6
    s_cmp_eq_u32 s6, 0
    s_cselect_b32 s7, 16, s7
    s_barrier
    v_mfma_f32_32x32x16_bf16 v[96:111], v[156:159], v[136:139], v[96:111]
    ds_read_b64_tr_b16 v[144:145], v10 offset:32768
    ds_read_b64_tr_b16 v[146:147], v10 offset:33280
    s_bitcmp1_b32 s70, 0
    s_cselect_b32 s25, s7, s6
    v_bfe_u32 v20, v0, 2, 1
    v_bfe_u32 v21, v0, 4, 1
    v_xor_b32 v20, v20, v21
    v_mfma_f32_32x32x16_bf16 v[112:127], v[156:159], v[140:143], v[112:127]
    ds_read_b128 v[128:131], v6 offset:32768
    ds_read_b64_tr_b16 v[148:149], v11 offset:32768
    s_add_u32 m0, s11, 12288
    s_nop 0
    buffer_load_dwordx4 v4, s[44:47], s10 offen lds
    s_add_u32 s79, s79, 1
    s_cmp_eq_u32 s79, 7
    s_cselect_b32 s15, -6, 1
    s_mul_i32 s14, s15, 128
    s_add_u32 s8, s8, s14
    s_add_u32 s0, s0, s14
    s_mul_i32 s14, s15, 229376
    s_add_u32 s9, s9, s14
    s_add_u32 s10, s10, s14
    v_and_b32 v21, 3, v0
    v_lshlrev_b32 v21, 4, v21
    v_lshl_add_u32 v21, v20, 6, v21
    v_lshrrev_b32 v20, 3, v0
    v_mfma_f32_32x32x16_bf16 v[80:95], v[152:155], v[140:143], v[80:95]
    ds_read_b64_tr_b16 v[150:151], v11 offset:33280
    ds_read_b128 v[132:135], v6 offset:36864
    s_add_u32 m0, s1, 114688
    s_nop 0
    buffer_load_dwordx4 v2, s[40:43], s8 offen lds
    v_mul_u32_u24 v40, 896, v20
    v_add_u32 v40, v40, v21
    v_add_u32 v41, 7168, v40
    s_mov_b32 s19, 0
    s_waitcnt lgkmcnt(0)
    v_mfma_f32_32x32x16_bf16 v[64:79], v[144:147], v[128:131], v[64:79]
    ds_read_b64_tr_b16 v[152:153], v10 offset:36864
    ds_read_b64_tr_b16 v[154:155], v10 offset:37376
    s_mul_i32 s18, s3, 14
    s_add_u32 s18, s18, s19
    s_mul_i32 s68, s18, 112
    s_add_u32 s68, s68, s71
    v_mfma_f32_32x32x16_bf16 v[96:111], v[148:151], v[128:131], v[96:111]
    ds_read_b128 v[136:139], v7 offset:32768
    ds_read_b64_tr_b16 v[156:157], v11 offset:36864
    s_add_u32 m0, s1, 122880
    s_nop 0
    buffer_load_dwordx4 v2, s[40:43], s0 offen lds
    s_lshl_b32 s68, s68, 7
    s_mov_b32 s20, s19
    s_mul_i32 s21, s70, 224
    s_add_u32 s21, s21, s18
    v_mfma_f32_32x32x16_bf16 v[112:127], v[148:151], v[132:135], v[112:127]
    ds_read_b64_tr_b16 v[158:159], v11 offset:37376
    ds_read_b128 v[140:143], v7 offset:36864
    s_lshl_b32 s21, s21, 10
    v_lshrrev_b32 v20, 5, v0
    v_lshlrev_b32 v36, 10, v20
    v_bfe_u32 v20, v0, 3, 1
    v_mfma_f32_32x32x16_bf16 v[80:95], v[144:147], v[132:135], v[80:95]
    s_add_u32 m0, s11, 16384
    s_nop 0
    buffer_load_dwordx4 v3, s[44:47], s9 offen lds
    v_lshl_or_b32 v36, v20, 8, v36
    v_lshl_or_b32 v36, v20, 6, v36
    v_bfe_u32 v20, v0, 2, 1
    v_lshl_or_b32 v36, v20, 7, v36
    s_waitcnt lgkmcnt(0)
    v_mfma_f32_32x32x16_bf16 v[64:79], v[152:155], v[136:139], v[64:79]
    ds_read_b64_tr_b16 v[144:145], v10 offset:40960
    ds_read_b64_tr_b16 v[146:147], v10 offset:41472
    v_bfe_u32 v20, v0, 4, 1
    v_lshl_or_b32 v36, v20, 5, v36
    v_and_b32 v20, 1, v0
    v_lshl_or_b32 v36, v20, 4, v36
    v_mfma_f32_32x32x16_bf16 v[96:111], v[156:159], v[136:139], v[96:111]
    ds_read_b128 v[128:131], v8 offset:32768
    ds_read_b64_tr_b16 v[148:149], v11 offset:40960
    s_add_u32 m0, s11, 20480
    s_nop 0
    buffer_load_dwordx4 v4, s[44:47], s9 offen lds
    v_bfe_u32 v20, v0, 1, 1
    v_lshl_or_b32 v36, v20, 3, v36
    v_add_u32 v36, s12, v36
    v_xor_b32 v37, 64, v36
    v_mfma_f32_32x32x16_bf16 v[112:127], v[156:159], v[140:143], v[112:127]
    ds_read_b64_tr_b16 v[150:151], v11 offset:41472
    ds_read_b128 v[132:135], v8 offset:36864
    v_add_u32 v38, 49152, v36
    v_add_u32 v39, 49152, v37
    v_add_u32 v16, 98304, v36
    v_add_u32 v17, 98304, v37
    v_mfma_f32_32x32x16_bf16 v[80:95], v[152:155], v[140:143], v[80:95]
    s_add_u32 m0, s11, 24576
    s_nop 0
    buffer_load_dwordx4 v3, s[44:47], s10 offen lds
    s_and_b32 s6, s3, 1
    s_lshl1_add_u32 s6, s4, s6
    s_mul_i32 s6, s6, 224
    s_lshl3_add_u32 s6, s5, s6
    s_waitcnt lgkmcnt(0)
    v_mfma_f32_32x32x16_bf16 v[64:79], v[144:147], v[128:131], v[64:79]
    ds_read_b64_tr_b16 v[152:153], v10 offset:45056
    ds_read_b64_tr_b16 v[154:155], v10 offset:45568
    s_add_u32 s22, s6, s3
    s_xor_b32 s7, s3, 1
    s_add_u32 s23, s6, s7
    s_lshl_b32 s22, s22, 10
    v_mfma_f32_32x32x16_bf16 v[96:111], v[148:151], v[128:131], v[96:111]
    ds_read_b128 v[136:139], v9 offset:32768
    ds_read_b64_tr_b16 v[156:157], v11 offset:45056
    s_add_u32 m0, s11, 28672
    s_nop 0
    buffer_load_dwordx4 v4, s[44:47], s10 offen lds
    s_add_u32 s79, s79, 1
    s_cmp_eq_u32 s79, 7
    s_cselect_b32 s15, -6, 1
    s_mul_i32 s14, s15, 128
    s_add_u32 s8, s8, s14
    s_add_u32 s0, s0, s14
    s_mul_i32 s14, s15, 229376
    s_add_u32 s9, s9, s14
    s_add_u32 s10, s10, s14
    s_lshl_b32 s23, s23, 10
    v_add_u32 v12, 114688, v1
    v_mfma_f32_32x32x16_bf16 v[112:127], v[148:151], v[132:135], v[112:127]
    ds_read_b64_tr_b16 v[158:159], v11 offset:45568
    ds_read_b128 v[140:143], v9 offset:36864
    v_mfma_f32_32x32x16_bf16 v[80:95], v[144:147], v[132:135], v[80:95]
    s_mov_b32 s52, s32
    s_and_b32 s53, s33, 0xffff
    s_mov_b32 s54, 1605632
    s_mov_b32 s55, 0x20000
    s_lshl3_add_u32 s14, s2, s3
    s_mul_i32 s14, s14, 896
    v_min_u32 v188, 6, v0
    v_lshlrev_b32 v188, 7, v188
    buffer_load_dword v187, v188, s[52:55], s14 offen
    s_waitcnt lgkmcnt(0)
    v_mfma_f32_32x32x16_bf16 v[64:79], v[152:155], v[136:139], v[64:79]
    s_waitcnt vmcnt(7)
    s_barrier
    v_mfma_f32_32x32x16_bf16 v[96:111], v[156:159], v[136:139], v[96:111]
    ds_read_b64_tr_b16 v[144:145], v10 offset:0
    ds_read_b64_tr_b16 v[146:147], v10 offset:512
    v_mfma_f32_32x32x16_bf16 v[112:127], v[156:159], v[140:143], v[112:127]
    ds_read_b128 v[128:131], v6 offset:0
    ds_read_b64_tr_b16 v[148:149], v11 offset:0
    v_mfma_f32_32x32x16_bf16 v[80:95], v[152:155], v[140:143], v[80:95]
    ds_read_b64_tr_b16 v[150:151], v11 offset:512
    ds_read_b128 v[132:135], v6 offset:4096
    s_add_u32 m0, s1, 131072
    s_nop 0
    buffer_load_dwordx4 v2, s[40:43], s8 offen lds
    s_waitcnt lgkmcnt(0)
    v_mfma_f32_32x32x16_bf16 v[64:79], v[144:147], v[128:131], v[64:79]
    ds_read_b64_tr_b16 v[152:153], v10 offset:4096
    ds_read_b64_tr_b16 v[154:155], v10 offset:4608
    v_mfma_f32_32x32x16_bf16 v[96:111], v[148:151], v[128:131], v[96:111]
    ds_read_b128 v[136:139], v7 offset:0
    ds_read_b64_tr_b16 v[156:157], v11 offset:4096
    s_add_u32 m0, s1, 139264
    s_nop 0
    buffer_load_dwordx4 v2, s[40:43], s0 offen lds
    v_mfma_f32_32x32x16_bf16 v[112:127], v[148:151], v[132:135], v[112:127]
    ds_read_b64_tr_b16 v[158:159], v11 offset:4608
    ds_read_b128 v[140:143], v7 offset:4096
    v_mfma_f32_32x32x16_bf16 v[80:95], v[144:147], v[132:135], v[80:95]
    s_add_u32 m0, s11, 32768
    s_nop 0
    buffer_load_dwordx4 v3, s[44:47], s9 offen lds
    s_waitcnt lgkmcnt(0)
    v_mfma_f32_32x32x16_bf16 v[64:79], v[152:155], v[136:139], v[64:79]
    ds_read_b64_tr_b16 v[144:145], v10 offset:8192
    ds_read_b64_tr_b16 v[146:147], v10 offset:8704
    v_mfma_f32_32x32x16_bf16 v[96:111], v[156:159], v[136:139], v[96:111]
    ds_read_b128 v[128:131], v8 offset:0
    ds_read_b64_tr_b16 v[148:149], v11 offset:8192
    s_add_u32 m0, s11, 36864
    s_nop 0
    buffer_load_dwordx4 v4, s[44:47], s9 offen lds
    v_mfma_f32_32x32x16_bf16 v[112:127], v[156:159], v[140:143], v[112:127]
    ds_read_b64_tr_b16 v[150:151], v11 offset:8704
    ds_read_b128 v[132:135], v8 offset:4096
    v_mfma_f32_32x32x16_bf16 v[80:95], v[152:155], v[140:143], v[80:95]
    s_add_u32 m0, s11, 40960
    s_nop 0
    buffer_load_dwordx4 v3, s[44:47], s10 offen lds
    s_waitcnt lgkmcnt(0)
    v_mfma_f32_32x32x16_bf16 v[64:79], v[144:147], v[128:131], v[64:79]
    ds_read_b64_tr_b16 v[152:153], v10 offset:12288
    ds_read_b64_tr_b16 v[154:155], v10 offset:12800
    v_mfma_f32_32x32x16_bf16 v[96:111], v[148:151], v[128:131], v[96:111]
    ds_read_b128 v[136:139], v9 offset:0
    ds_read_b64_tr_b16 v[156:157], v11 offset:12288
    s_add_u32 m0, s11, 45056
    s_nop 0
    buffer_load_dwordx4 v4, s[44:47], s10 offen lds
    s_add_u32 s79, s79, 1
    s_cmp_eq_u32 s79, 7
    s_cselect_b32 s15, -6, 1
    s_mul_i32 s14, s15, 128
    s_add_u32 s8, s8, s14
    s_add_u32 s0, s0, s14
    s_mul_i32 s14, s15, 229376
    s_add_u32 s9, s9, s14
    s_add_u32 s10, s10, s14
    v_mfma_f32_32x32x16_bf16 v[112:127], v[148:151], v[132:135], v[112:127]
    ds_read_b64_tr_b16 v[158:159], v11 offset:12800
    ds_read_b128 v[140:143], v9 offset:4096
    v_mfma_f32_32x32x16_bf16 v[80:95], v[144:147], v[132:135], v[80:95]
    s_waitcnt lgkmcnt(0)
    v_mfma_f32_32x32x16_bf16 v[64:79], v[152:155], v[136:139], v[64:79]
    s_waitcnt vmcnt(7)
    s_barrier
    v_mfma_f32_32x32x16_bf16 v[96:111], v[156:159], v[136:139], v[96:111]
    ds_read_b64_tr_b16 v[144:145], v10 offset:16384
    ds_read_b64_tr_b16 v[146:147], v10 offset:16896
    v_mfma_f32_32x32x16_bf16 v[112:127], v[156:159], v[140:143], v[112:127]
    ds_read_b128 v[128:131], v6 offset:16384
    ds_read_b64_tr_b16 v[148:149], v11 offset:16384
    s_add_u32 m0, s1, 98304
    s_nop 0
    buffer_load_dwordx4 v2, s[40:43], s8 offen lds
    v_mfma_f32_32x32x16_bf16 v[80:95], v[152:155], v[140:143], v[80:95]
    ds_read_b64_tr_b16 v[150:151], v11 offset:16896
    ds_read_b128 v[132:135], v6 offset:20480
    s_add_u32 m0, s1, 106496
    s_nop 0
    buffer_load_dwordx4 v2, s[40:43], s0 offen lds
    s_waitcnt lgkmcnt(0)
    v_mfma_f32_32x32x16_bf16 v[64:79], v[144:147], v[128:131], v[64:79]
    ds_read_b64_tr_b16 v[152:153], v10 offset:20480
    ds_read_b64_tr_b16 v[154:155], v10 offset:20992
    v_mfma_f32_32x32x16_bf16 v[96:111], v[148:151], v[128:131], v[96:111]
    ds_read_b128 v[136:139], v7 offset:16384
    ds_read_b64_tr_b16 v[156:157], v11 offset:20480
    s_add_u32 m0, s11, 0
    s_nop 0
    buffer_load_dwordx4 v3, s[44:47], s9 offen lds
    v_mfma_f32_32x32x16_bf16 v[112:127], v[148:151], v[132:135], v[112:127]
    ds_read_b64_tr_b16 v[158:159], v11 offset:20992
    ds_read_b128 v[140:143], v7 offset:20480
    v_mfma_f32_32x32x16_bf16 v[80:95], v[144:147], v[132:135], v[80:95]
    s_add_u32 m0, s11, 4096
    s_nop 0
    buffer_load_dwordx4 v4, s[44:47], s9 offen lds
    s_waitcnt lgkmcnt(0)
    v_mfma_f32_32x32x16_bf16 v[64:79], v[152:155], v[136:139], v[64:79]
    ds_read_b64_tr_b16 v[144:145], v10 offset:24576
    ds_read_b64_tr_b16 v[146:147], v10 offset:25088
    v_mfma_f32_32x32x16_bf16 v[96:111], v[156:159], v[136:139], v[96:111]
    ds_read_b128 v[128:131], v8 offset:16384
    ds_read_b64_tr_b16 v[148:149], v11 offset:24576
    s_add_u32 m0, s11, 8192
    s_nop 0
    buffer_load_dwordx4 v3, s[44:47], s10 offen lds
    v_mfma_f32_32x32x16_bf16 v[112:127], v[156:159], v[140:143], v[112:127]
    ds_read_b64_tr_b16 v[150:151], v11 offset:25088
    ds_read_b128 v[132:135], v8 offset:20480
    v_mfma_f32_32x32x16_bf16 v[80:95], v[152:155], v[140:143], v[80:95]
    s_add_u32 m0, s11, 12288
    s_nop 0
    buffer_load_dwordx4 v4, s[44:47], s10 offen lds
    s_waitcnt lgkmcnt(0)
    v_mfma_f32_32x32x16_bf16 v[64:79], v[144:147], v[128:131], v[64:79]
    ds_read_b64_tr_b16 v[152:153], v10 offset:28672
    ds_read_b64_tr_b16 v[154:155], v10 offset:29184
    v_mfma_f32_32x32x16_bf16 v[96:111], v[148:151], v[128:131], v[96:111]
    ds_read_b128 v[136:139], v9 offset:16384
    ds_read_b64_tr_b16 v[156:157], v11 offset:28672
    s_add_u32 m0, s12, 147456
    s_nop 0
    buffer_load_dwordx4 v1, s[56:59], s77 offen sc1 lds
    v_mfma_f32_32x32x16_bf16 v[112:127], v[148:151], v[132:135], v[112:127]
    ds_read_b64_tr_b16 v[158:159], v11 offset:29184
    ds_read_b128 v[140:143], v9 offset:20480
    v_lshrrev_b32 v20, 3, v0
    v_and_b32 v21, 7, v0
    v_mul_u32_u24 v18, 57344, v20
    v_lshl_add_u32 v18, v21, 4, v18
    v_mfma_f32_32x32x16_bf16 v[80:95], v[144:147], v[132:135], v[80:95]
    s_add_u32 m0, s12, 147456
    s_nop 0
    buffer_load_dwordx4 v1, s[56:59], s77 offen offset:1024 sc1 lds
    s_lshr_b32 s6, s3, 2
    s_lshl_b32 s6, s6, 5
    s_xor_b32 s6, s6, s25
    s_and_b32 s7, s3, 3
    s_waitcnt lgkmcnt(0)
    v_mfma_f32_32x32x16_bf16 v[64:79], v[152:155], v[136:139], v[64:79]
    s_lshl_b32 s7, s7, 9
    s_add_u32 s6, s6, s7
    s_mul_i32 s74, s6, 7
    s_add_u32 s74, s74, s71
    s_waitcnt vmcnt(8)
    s_barrier
    v_mfma_f32_32x32x16_bf16 v[96:111], v[156:159], v[136:139], v[96:111]
    ds_read_b64_tr_b16 v[144:145], v10 offset:32768
    ds_read_b64_tr_b16 v[146:147], v10 offset:33280
    s_lshl_b32 s74, s74, 7
    buffer_load_dwordx4 v[2:5], v18, s[40:43], s74 offen
    v_mfma_f32_32x32x16_bf16 v[112:127], v[156:159], v[140:143], v[112:127]
    ds_read_b128 v[128:131], v6 offset:32768
    ds_read_b64_tr_b16 v[148:149], v11 offset:32768
    v_mfma_f32_32x32x16_bf16 v[80:95], v[152:155], v[140:143], v[80:95]
    ds_read_b64_tr_b16 v[150:151], v11 offset:33280
    ds_read_b128 v[132:135], v6 offset:36864
    s_add_u32 m0, s12, 16384
    s_nop 0
    buffer_load_dwordx4 v40, s[52:55], s68 offen lds
    s_waitcnt lgkmcnt(0)
    v_mfma_f32_32x32x16_bf16 v[64:79], v[144:147], v[128:131], v[64:79]
    ds_read_b64_tr_b16 v[152:153], v10 offset:36864
    ds_read_b64_tr_b16 v[154:155], v10 offset:37376
    v_mfma_f32_32x32x16_bf16 v[96:111], v[148:151], v[128:131], v[96:111]
    ds_read_b128 v[136:139], v7 offset:32768
    ds_read_b64_tr_b16 v[156:157], v11 offset:36864
    s_add_u32 m0, s12, 17408
    s_nop 0
    buffer_load_dwordx4 v41, s[52:55], s68 offen lds
    s_add_u32 s19, s19, 1
    s_cmp_eq_u32 s19, 14
    s_cselect_b32 s15, -13, 1
    s_mul_i32 s15, s15, 14336
    s_add_u32 s68, s68, s15
    v_mfma_f32_32x32x16_bf16 v[112:127], v[148:151], v[132:135], v[112:127]
    ds_read_b64_tr_b16 v[158:159], v11 offset:37376
    ds_read_b128 v[140:143], v7 offset:36864
    v_mfma_f32_32x32x16_bf16 v[80:95], v[144:147], v[132:135], v[80:95]
    s_add_u32 m0, s12, 65536
    s_nop 0
    buffer_load_dwordx4 v40, s[52:55], s68 offen lds
    s_waitcnt lgkmcnt(0)
    v_mfma_f32_32x32x16_bf16 v[64:79], v[152:155], v[136:139], v[64:79]
    ds_read_b64_tr_b16 v[144:145], v10 offset:40960
    ds_read_b64_tr_b16 v[146:147], v10 offset:41472
    v_mfma_f32_32x32x16_bf16 v[96:111], v[156:159], v[136:139], v[96:111]
    ds_read_b128 v[128:131], v8 offset:32768
    ds_read_b64_tr_b16 v[148:149], v11 offset:40960
    s_add_u32 m0, s12, 66560
    s_nop 0
    buffer_load_dwordx4 v41, s[52:55], s68 offen lds
    s_add_u32 s19, s19, 1
    s_cmp_eq_u32 s19, 14
    s_cselect_b32 s15, -13, 1
    s_mul_i32 s15, s15, 14336
    s_add_u32 s68, s68, s15
    v_mfma_f32_32x32x16_bf16 v[112:127], v[156:159], v[140:143], v[112:127]
    ds_read_b64_tr_b16 v[150:151], v11 offset:41472
    ds_read_b128 v[132:135], v8 offset:36864
    v_mfma_f32_32x32x16_bf16 v[80:95], v[152:155], v[140:143], v[80:95]
    s_add_u32 m0, s12, 114688
    s_nop 0
    buffer_load_dwordx4 v40, s[52:55], s68 offen lds
    s_waitcnt lgkmcnt(0)
    v_mfma_f32_32x32x16_bf16 v[64:79], v[144:147], v[128:131], v[64:79]
    ds_read_b64_tr_b16 v[152:153], v10 offset:45056
    ds_read_b64_tr_b16 v[154:155], v10 offset:45568
    v_mfma_f32_32x32x16_bf16 v[96:111], v[148:151], v[128:131], v[96:111]
    ds_read_b128 v[136:139], v9 offset:32768
    ds_read_b64_tr_b16 v[156:157], v11 offset:45056
    s_add_u32 m0, s12, 115712
    s_nop 0
    buffer_load_dwordx4 v41, s[52:55], s68 offen lds
    s_add_u32 s19, s19, 1
    s_cmp_eq_u32 s19, 14
    s_cselect_b32 s15, -13, 1
    s_mul_i32 s15, s15, 14336
    s_add_u32 s68, s68, s15
    v_mfma_f32_32x32x16_bf16 v[112:127], v[148:151], v[132:135], v[112:127]
    ds_read_b64_tr_b16 v[158:159], v11 offset:45568
    ds_read_b128 v[140:143], v9 offset:36864
    v_mfma_f32_32x32x16_bf16 v[80:95], v[144:147], v[132:135], v[80:95]
    s_waitcnt lgkmcnt(0)
    v_mfma_f32_32x32x16_bf16 v[64:79], v[152:155], v[136:139], v[64:79]
    s_waitcnt vmcnt(7)
    s_barrier
    v_mfma_f32_32x32x16_bf16 v[96:111], v[156:159], v[136:139], v[96:111]
    ds_read_b64_tr_b16 v[144:145], v10 offset:0
    ds_read_b64_tr_b16 v[146:147], v10 offset:512
    v_mfma_f32_32x32x16_bf16 v[112:127], v[156:159], v[140:143], v[112:127]
    ds_read_b128 v[128:131], v6 offset:0
    ds_read_b64_tr_b16 v[148:149], v11 offset:0
    ds_read_b64 v[44:45], v60
    ds_read_b64 v[46:47], v60 offset:256
    ds_read_b64 v[160:161], v13 offset:0
    ds_read_b64 v[162:163], v13 offset:2048
    v_mfma_f32_32x32x16_bf16 v[80:95], v[152:155], v[140:143], v[80:95]
    ds_read_b64_tr_b16 v[150:151], v11 offset:512
    ds_read_b128 v[132:135], v6 offset:4096
    s_add_u32 m0, s12, 32768
    s_nop 0
    buffer_load_dwordx4 v40, s[52:55], s68 offen lds
    ds_read_b64 v[164:165], v13 offset:4096
    ds_read_b64 v[166:167], v13 offset:6144
    ds_read_b64 v[168:169], v13 offset:8192
    ds_read_b64 v[170:171], v13 offset:10240
    s_waitcnt lgkmcnt(0)
    v_mfma_f32_32x32x16_bf16 v[64:79], v[144:147], v[128:131], v[64:79]
    ds_read_b64_tr_b16 v[152:153], v10 offset:4096
    ds_read_b64_tr_b16 v[154:155], v10 offset:4608
    ds_read_b64 v[172:173], v13 offset:12288
    v_mfma_f32_32x32x16_bf16 v[96:111], v[148:151], v[128:131], v[96:111]
    ds_read_b128 v[136:139], v7 offset:0
    ds_read_b64_tr_b16 v[156:157], v11 offset:4096
    s_add_u32 m0, s12, 33792
    s_nop 0
    buffer_load_dwordx4 v41, s[52:55], s68 offen lds
    s_add_u32 s19, s19, 1
    s_cmp_eq_u32 s19, 14
    s_cselect_b32 s15, -13, 1
    s_mul_i32 s15, s15, 14336
    s_add_u32 s68, s68, s15
    v_mfma_f32_32x32x16_bf16 v[112:127], v[148:151], v[132:135], v[112:127]
    ds_read_b64_tr_b16 v[158:159], v11 offset:4608
    ds_read_b128 v[140:143], v7 offset:4096
    s_waitcnt vmcnt(6)
    ds_read_b64_tr_b16 v[184:185], v36 offset:16384
    ds_read_b64_tr_b16 v[186:187], v36 offset:16896
    v_mfma_f32_32x32x16_bf16 v[80:95], v[144:147], v[132:135], v[80:95]
    s_add_u32 m0, s12, 81920
    s_nop 0
    buffer_load_dwordx4 v40, s[52:55], s68 offen lds
    ds_read_b64_tr_b16 v[188:189], v37 offset:16384
    ds_read_b64_tr_b16 v[190:191], v37 offset:16896
    s_waitcnt lgkmcnt(0)
    v_mfma_f32_32x32x16_bf16 v[64:79], v[152:155], v[136:139], v[64:79]
    ds_read_b64_tr_b16 v[144:145], v10 offset:8192
    ds_read_b64_tr_b16 v[146:147], v10 offset:8704
    v_min3_u32 v20, v45, v47, v161
    v_max3_u32 v21, v45, v47, v161
    v_min3_u32 v20, v20, v163, v165
    v_max3_u32 v21, v21, v163, v165
    s_waitcnt vmcnt(5)
    ds_read_b64_tr_b16 v[192:193], v38 offset:16384
    ds_read_b64_tr_b16 v[194:195], v38 offset:16896
    v_mfma_f32_32x32x16_bf16 v[96:111], v[156:159], v[136:139], v[96:111]
    ds_read_b128 v[128:131], v8 offset:0
    ds_read_b64_tr_b16 v[148:149], v11 offset:8192
    s_add_u32 m0, s12, 82944
    s_nop 0
    buffer_load_dwordx4 v41, s[52:55], s68 offen lds
    s_add_u32 s19, s19, 1
    s_cmp_eq_u32 s19, 14
    s_cselect_b32 s15, -13, 1
    s_mul_i32 s15, s15, 14336
    s_add_u32 s68, s68, s15
    v_min3_u32 v20, v20, v167, v169
    v_max3_u32 v21, v21, v167, v169
    v_min3_u32 v20, v20, v171, v173
    v_max3_u32 v21, v21, v171, v173
    ds_read_b64_tr_b16 v[196:197], v39 offset:16384
    ds_read_b64_tr_b16 v[198:199], v39 offset:16896
    v_mfma_f32_32x32x16_bf16 v[112:127], v[156:159], v[140:143], v[112:127]
    ds_read_b64_tr_b16 v[150:151], v11 offset:8704
    ds_read_b128 v[132:135], v8 offset:4096
    v_xor_b32 v20, s78, v20
    v_xor_b32 v21, s78, v21
    v_or_b32 v20, v20, v21
    v_cmp_ne_u32 vcc, 0, v20
    s_nop 1
    s_cbranch_vccz L_ok1
    s_mov_b32 s75, 0x10000
L_spin1:
    s_sleep 1
    buffer_load_dwordx2 v[44:45], v42, s[56:59], 0 offen sc1
    buffer_load_dwordx2 v[46:47], v42, s[56:59], 0 offen offset:256 sc1
    s_mov_b32 s6, 0
    buffer_load_dwordx2 v[160:161], v43, s[56:59], s6 offen sc1
    s_add_u32 s6, s6, 2048
    buffer_load_dwordx2 v[162:163], v43, s[56:59], s6 offen sc1
    s_add_u32 s6, s6, 2048
    buffer_load_dwordx2 v[164:165], v43, s[56:59], s6 offen sc1
    s_add_u32 s6, s6, 2048
    buffer_load_dwordx2 v[166:167], v43, s[56:59], s6 offen sc1
    s_add_u32 s6, s6, 2048
    buffer_load_dwordx2 v[168:169], v43, s[56:59], s6 offen sc1
    s_add_u32 s6, s6, 2048
    buffer_load_dwordx2 v[170:171], v43, s[56:59], s6 offen sc1
    s_add_u32 s6, s6, 2048
    buffer_load_dwordx2 v[172:173], v43, s[56:59], s6 offen sc1
    s_add_u32 s6, s6, 2048
    s_waitcnt vmcnt(0)
    v_min3_u32 v20, v45, v47, v161
    v_max3_u32 v21, v45, v47, v161
    v_min3_u32 v20, v20, v163, v165
    v_max3_u32 v21, v21, v163, v165
    v_min3_u32 v20, v20, v167, v169
    v_max3_u32 v21, v21, v167, v169
    v_min3_u32 v20, v20, v171, v173
    v_max3_u32 v21, v21, v171, v173
    v_xor_b32 v20, s78, v20
    v_xor_b32 v21, s78, v21
    v_or_b32 v20, v20, v21
    v_cmp_ne_u32 vcc, 0, v20
    s_nop 1
    s_cbranch_vccz L_ok1
    s_sub_u32 s75, s75, 1
    s_cmp_lg_u32 s75, 0
    s_cbranch_scc1 L_spin1
L_ok1:
    s_waitcnt vmcnt(4)
    ds_read_b64_tr_b16 v[200:201], v16 offset:16384
    ds_read_b64_tr_b16 v[202:203], v16 offset:16896
    v_mfma_f32_32x32x16_bf16 v[80:95], v[152:155], v[140:143], v[80:95]
    s_add_u32 m0, s12, 131072
    s_nop 0
    buffer_load_dwordx4 v40, s[52:55], s68 offen lds
    v_add_f32 v160, v160, v162
    v_add_f32 v160, v160, v164
    v_add_f32 v160, v160, v166
    v_add_f32 v160, v160, v168
    ds_read_b64_tr_b16 v[204:205], v17 offset:16384
    ds_read_b64_tr_b16 v[206:207], v17 offset:16896
    s_waitcnt lgkmcnt(0)
    v_mfma_f32_32x32x16_bf16 v[64:79], v[144:147], v[128:131], v[64:79]
    ds_read_b64_tr_b16 v[152:153], v10 offset:12288
    ds_read_b64_tr_b16 v[154:155], v10 offset:12800
    v_add_f32 v160, v160, v170
    v_add_f32 v160, v160, v172
    v_and_b32 v20, 0xffff0000, v160
    v_sub_f32 v21, v160, v20
    v_mfma_f32_32x32x16_bf16 v[96:111], v[148:151], v[128:131], v[96:111]
    ds_read_b128 v[136:139], v9 offset:0
    ds_read_b64_tr_b16 v[156:157], v11 offset:12288
    s_add_u32 m0, s12, 132096
    s_nop 0
    buffer_load_dwordx4 v41, s[52:55], s68 offen lds
    s_add_u32 s19, s19, 1
    s_cmp_eq_u32 s19, 14
    s_cselect_b32 s15, -13, 1
    s_mul_i32 s15, s15, 14336
    s_add_u32 s68, s68, s15
    v_and_b32 v22, 0xffff0000, v21
    v_sub_f32 v21, v21, v22
    v_lshrrev_b32 v20, 16, v20
    v_or_b32 v54, v20, v22
    v_mfma_f32_32x32x16_bf16 v[112:127], v[148:151], v[132:135], v[112:127]
    ds_read_b64_tr_b16 v[158:159], v11 offset:12800
    ds_read_b128 v[140:143], v9 offset:4096
    v_lshrrev_b32 v55, 16, v21
    v_cmp_gt_u32 vcc, 32, v0
    v_and_b32 v20, 0xffff, v44
    v_xor_b32 v20, 0x8000, v20
    v_mfma_f32_32x32x16_bf16 v[80:95], v[144:147], v[132:135], v[80:95]
    v_lshl_or_b32 v21, v20, 16, v20
    v_cndmask_b32 v176, 0, v21, vcc
    v_cndmask_b32 v177, 0, v20, vcc
    v_cndmask_b32 v180, v21, v61, vcc
    s_waitcnt lgkmcnt(0)
    v_mfma_f32_32x32x16_bf16 v[64:79], v[152:155], v[136:139], v[64:79]
    v_cndmask_b32 v181, v20, v61, vcc
    v_and_b32 v45, 0xffff0000, v44
    v_and_b32 v20, 0xffff, v46
    v_xor_b32 v20, 0x8000, v20
    s_barrier
    v_mfma_f32_32x32x16_bf16 v[96:111], v[156:159], v[136:139], v[96:111]
    v_lshl_or_b32 v21, v20, 16, v20
    v_cndmask_b32 v178, 0, v21, vcc
    v_cndmask_b32 v179, 0, v20, vcc
    v_cndmask_b32 v182, v21, v61, vcc
    v_mfma_f32_32x32x16_bf16 v[112:127], v[156:159], v[140:143], v[112:127]
    s_add_u32 m0, s12, 16384
    s_nop 0
    buffer_load_dwordx4 v40, s[52:55], s68 offen lds
    v_cndmask_b32 v183, v20, v61, vcc
    v_and_b32 v47, 0xffff0000, v46
    v_mfma_f32_32x32x16_bf16 v[80:95], v[152:155], v[140:143], v[80:95]
    s_add_u32 m0, s12, 17408
    s_nop 0
    buffer_load_dwordx4 v41, s[52:55], s68 offen lds
    s_add_u32 s19, s19, 1
    s_cmp_eq_u32 s19, 14
    s_cselect_b32 s15, -13, 1
    s_mul_i32 s15, s15, 14336
    s_add_u32 s68, s68, s15
    v_mfma_f32_32x32x8_bf16 v[64:79], v[54:55], v[176:177], v[64:79]
    v_mfma_f32_32x32x8_bf16 v[96:111], v[54:55], v[180:181], v[96:111]
    v_mfma_f32_32x32x8_bf16 v[112:127], v[54:55], v[182:183], v[112:127]
    v_mfma_f32_32x32x8_bf16 v[80:95], v[54:55], v[178:179], v[80:95]
    v_rcp_f32 v22, v45
    v_mul_f32 v52, v45, v45
    v_mul_f32 v53, v45, v45
    v_rcp_f32 v23, v47
    v_mul_f32 v54, v47, v47
    v_mul_f32 v55, v47, v47
    v_mul_f32 v48, 0xc0135761, v22
    v_mul_f32 v49, 0xc0135761, v22
    v_mul_f32 v22, v22, v22
    v_mul_f32 v58, 0xc0135761, v23
    v_mul_f32 v59, 0xc0135761, v23
    v_mul_f32 v23, v23, v23
    v_mul_f32 v22, 0x3d372713, v22
    v_mul_f32 v23, 0x3d372713, v23
    v_mul_f32 v50, v48, v22
    v_mul_f32 v51, v48, v22
    v_mul_f32 v42, v58, v23
    v_mul_f32 v43, v58, v23
    s_add_u32 m0, s12, 65536
    s_nop 0
    buffer_load_dwordx4 v40, s[52:55], s68 offen lds
    s_add_u32 m0, s12, 66560
    s_nop 0
    buffer_load_dwordx4 v41, s[52:55], s68 offen lds
    s_add_u32 s19, s19, 1
    s_cmp_eq_u32 s19, 14
    s_cselect_b32 s15, -13, 1
    s_mul_i32 s15, s15, 14336
    s_add_u32 s68, s68, s15
    s_add_u32 m0, s12, 114688
    s_nop 0
    buffer_load_dwordx4 v40, s[52:55], s68 offen lds
    s_add_u32 m0, s12, 115712
    s_nop 0
    buffer_load_dwordx4 v41, s[52:55], s68 offen lds
    s_add_u32 s19, s19, 1
    s_cmp_eq_u32 s19, 14
    s_cselect_b32 s15, -13, 1
    s_mul_i32 s15, s15, 14336
    s_add_u32 s68, s68, s15
    s_cmp_lg_u32 s3, 0
    s_cselect_b32 s72, 2130706432, s72
    v_pk_mul_f32 v[20:21], v[64:65], v[64:65]
    v_pk_mul_f32 v[22:23], v[66:67], v[66:67]
    v_pk_mul_f32 v[24:25], v[68:69], v[68:69]
    v_pk_mul_f32 v[26:27], v[70:71], v[70:71]
    v_pk_fma_f32 v[20:21], v[20:21], v[50:51], v[48:49]
    v_pk_fma_f32 v[22:23], v[22:23], v[50:51], v[48:49]
    v_pk_fma_f32 v[24:25], v[24:25], v[50:51], v[48:49]
    v_pk_fma_f32 v[26:27], v[26:27], v[50:51], v[48:49]
    v_pk_mul_f32 v[20:21], v[20:21], v[64:65]
    v_pk_mul_f32 v[22:23], v[22:23], v[66:67]
    v_pk_mul_f32 v[24:25], v[24:25], v[68:69]
    v_pk_mul_f32 v[26:27], v[26:27], v[70:71]
    v_exp_f32 v20, v20
    v_exp_f32 v21, v21
    v_exp_f32 v22, v22
    v_exp_f32 v23, v23
    v_exp_f32 v24, v24
    v_exp_f32 v25, v25
    v_exp_f32 v26, v26
    v_exp_f32 v27, v27
    v_pk_mul_f32 v[72:73], v[72:73], v[64:65]
    v_pk_mul_f32 v[74:75], v[74:75], v[66:67]
    v_pk_mul_f32 v[76:77], v[76:77], v[68:69]
    v_pk_mul_f32 v[78:79], v[78:79], v[70:71]
    v_pk_fma_f32 v[20:21], v[20:21], v[52:53], v[52:53]
    v_pk_fma_f32 v[22:23], v[22:23], v[52:53], v[52:53]
    v_pk_fma_f32 v[24:25], v[24:25], v[52:53], v[52:53]
    v_pk_fma_f32 v[26:27], v[26:27], v[52:53], v[52:53]
    v_rcp_f32 v20, v20
    v_rcp_f32 v21, v21
    v_rcp_f32 v22, v22
    v_rcp_f32 v23, v23
    v_rcp_f32 v24, v24
    v_rcp_f32 v25, v25
    v_rcp_f32 v26, v26
    v_rcp_f32 v27, v27
    v_pk_mul_f32 v[72:73], v[72:73], v[20:21]
    v_pk_mul_f32 v[74:75], v[74:75], v[22:23]
    v_pk_mul_f32 v[76:77], v[76:77], v[24:25]
    v_pk_mul_f32 v[78:79], v[78:79], v[26:27]
    v_cvt_pk_bf16_f32 v28, v72, v73
    v_cvt_pk_bf16_f32 v29, v74, v75
    v_cvt_pk_bf16_f32 v30, v76, v77
    v_cvt_pk_bf16_f32 v31, v78, v79
    buffer_store_dwordx4 v[28:31], v1, s[56:59], s22 offen sc1
    v_pk_mul_f32 v[20:21], v[96:97], v[96:97]
    v_pk_mul_f32 v[22:23], v[98:99], v[98:99]
    v_pk_mul_f32 v[24:25], v[100:101], v[100:101]
    v_pk_mul_f32 v[26:27], v[102:103], v[102:103]
    v_pk_fma_f32 v[20:21], v[20:21], v[50:51], v[48:49]
    v_pk_fma_f32 v[22:23], v[22:23], v[50:51], v[48:49]
    v_pk_fma_f32 v[24:25], v[24:25], v[50:51], v[48:49]
    s_waitcnt vmcnt(11)
    ds_read_b64_tr_b16 v[208:209], v36 offset:32768
    ds_read_b64_tr_b16 v[210:211], v36 offset:33280
    v_pk_fma_f32 v[26:27], v[26:27], v[50:51], v[48:49]
    v_pk_mul_f32 v[20:21], v[20:21], v[96:97]
    v_pk_mul_f32 v[22:23], v[22:23], v[98:99]
    v_pk_mul_f32 v[24:25], v[24:25], v[100:101]
    v_pk_mul_f32 v[26:27], v[26:27], v[102:103]
    v_exp_f32 v20, v20
    v_exp_f32 v21, v21
    ds_read_b64_tr_b16 v[212:213], v37 offset:32768
    ds_read_b64_tr_b16 v[214:215], v37 offset:33280
    v_exp_f32 v22, v22
    v_exp_f32 v23, v23
    v_exp_f32 v24, v24
    v_exp_f32 v25, v25
    v_exp_f32 v26, v26
    v_exp_f32 v27, v27
    v_pk_mul_f32 v[104:105], v[104:105], v[96:97]
    s_waitcnt vmcnt(9)
    ds_read_b64_tr_b16 v[216:217], v38 offset:32768
    ds_read_b64_tr_b16 v[218:219], v38 offset:33280
    v_pk_mul_f32 v[106:107], v[106:107], v[98:99]
    v_pk_mul_f32 v[108:109], v[108:109], v[100:101]
    v_pk_mul_f32 v[110:111], v[110:111], v[102:103]
    v_pk_fma_f32 v[20:21], v[20:21], v[52:53], v[52:53]
    v_pk_fma_f32 v[22:23], v[22:23], v[52:53], v[52:53]
    v_pk_fma_f32 v[24:25], v[24:25], v[52:53], v[52:53]
    v_pk_fma_f32 v[26:27], v[26:27], v[52:53], v[52:53]
    ds_read_b64_tr_b16 v[220:221], v39 offset:32768
    ds_read_b64_tr_b16 v[222:223], v39 offset:33280
    v_rcp_f32 v20, v20
    v_rcp_f32 v21, v21
    v_rcp_f32 v22, v22
    v_rcp_f32 v23, v23
    v_rcp_f32 v24, v24
    v_rcp_f32 v25, v25
    v_rcp_f32 v26, v26
    s_waitcnt vmcnt(7)
    ds_read_b64_tr_b16 v[224:225], v16 offset:32768
    ds_read_b64_tr_b16 v[226:227], v16 offset:33280
    v_rcp_f32 v27, v27
    v_pk_mul_f32 v[104:105], v[104:105], v[20:21]
    v_pk_mul_f32 v[106:107], v[106:107], v[22:23]
    v_pk_mul_f32 v[108:109], v[108:109], v[24:25]
    v_pk_mul_f32 v[110:111], v[110:111], v[26:27]
    v_cvt_pk_bf16_f32 v32, v104, v105
    v_cvt_pk_bf16_f32 v33, v106, v107
    ds_read_b64_tr_b16 v[228:229], v17 offset:32768
    ds_read_b64_tr_b16 v[230:231], v17 offset:33280
    v_cvt_pk_bf16_f32 v34, v108, v109
    v_cvt_pk_bf16_f32 v35, v110, v111
    buffer_store_dwordx4 v[32:35], v1, s[56:59], s23 offen sc1
    v_pk_mul_f32 v[20:21], v[112:113], v[112:113]
    v_pk_mul_f32 v[22:23], v[114:115], v[114:115]
    v_pk_mul_f32 v[24:25], v[116:117], v[116:117]
    v_pk_mul_f32 v[26:27], v[118:119], v[118:119]
    v_pk_fma_f32 v[20:21], v[20:21], v[42:43], v[58:59]
    v_pk_fma_f32 v[22:23], v[22:23], v[42:43], v[58:59]
    v_pk_fma_f32 v[24:25], v[24:25], v[42:43], v[58:59]
    v_pk_fma_f32 v[26:27], v[26:27], v[42:43], v[58:59]
    v_pk_mul_f32 v[20:21], v[20:21], v[112:113]
    v_pk_mul_f32 v[22:23], v[22:23], v[114:115]
    v_pk_mul_f32 v[24:25], v[24:25], v[116:117]
    v_pk_mul_f32 v[26:27], v[26:27], v[118:119]
    v_exp_f32 v20, v20
    v_exp_f32 v21, v21
    v_exp_f32 v22, v22
    v_exp_f32 v23, v23
    v_exp_f32 v24, v24
    v_exp_f32 v25, v25
    v_exp_f32 v26, v26
    v_exp_f32 v27, v27
    v_pk_mul_f32 v[120:121], v[120:121], v[112:113]
    v_pk_mul_f32 v[122:123], v[122:123], v[114:115]
    v_pk_mul_f32 v[124:125], v[124:125], v[116:117]
    v_pk_mul_f32 v[126:127], v[126:127], v[118:119]
    v_pk_fma_f32 v[20:21], v[20:21], v[54:55], v[54:55]
    v_pk_fma_f32 v[22:23], v[22:23], v[54:55], v[54:55]
    v_pk_fma_f32 v[24:25], v[24:25], v[54:55], v[54:55]
    v_pk_fma_f32 v[26:27], v[26:27], v[54:55], v[54:55]
    v_rcp_f32 v20, v20
    v_rcp_f32 v21, v21
    v_rcp_f32 v22, v22
    v_rcp_f32 v23, v23
    v_rcp_f32 v24, v24
    v_rcp_f32 v25, v25
    v_rcp_f32 v26, v26
    v_rcp_f32 v27, v27
    v_pk_mul_f32 v[120:121], v[120:121], v[20:21]
    v_pk_mul_f32 v[122:123], v[122:123], v[22:23]
    v_pk_mul_f32 v[124:125], v[124:125], v[24:25]
    v_pk_mul_f32 v[126:127], v[126:127], v[26:27]
    v_cvt_pk_bf16_f32 v28, v120, v121
    v_cvt_pk_bf16_f32 v29, v122, v123
    v_cvt_pk_bf16_f32 v30, v124, v125
    v_cvt_pk_bf16_f32 v31, v126, v127
    buffer_store_dwordx4 v[28:31], v12, s[56:59], s23 offen sc1
    v_pk_mul_f32 v[20:21], v[80:81], v[80:81]
    v_pk_mul_f32 v[22:23], v[82:83], v[82:83]
    v_pk_mul_f32 v[24:25], v[84:85], v[84:85]
    v_pk_mul_f32 v[26:27], v[86:87], v[86:87]
    v_pk_fma_f32 v[20:21], v[20:21], v[42:43], v[58:59]
    v_pk_fma_f32 v[22:23], v[22:23], v[42:43], v[58:59]
    v_pk_fma_f32 v[24:25], v[24:25], v[42:43], v[58:59]
    v_pk_fma_f32 v[26:27], v[26:27], v[42:43], v[58:59]
    v_pk_mul_f32 v[20:21], v[20:21], v[80:81]
    v_pk_mul_f32 v[22:23], v[22:23], v[82:83]
    v_pk_mul_f32 v[24:25], v[24:25], v[84:85]
    v_pk_mul_f32 v[26:27], v[26:27], v[86:87]
    v_exp_f32 v20, v20
    v_exp_f32 v21, v21
    v_exp_f32 v22, v22
    v_exp_f32 v23, v23
    v_exp_f32 v24, v24
    v_exp_f32 v25, v25
    v_exp_f32 v26, v26
    v_exp_f32 v27, v27
    v_pk_mul_f32 v[88:89], v[88:89], v[80:81]
    v_pk_mul_f32 v[90:91], v[90:91], v[82:83]
    v_pk_mul_f32 v[92:93], v[92:93], v[84:85]
    v_pk_mul_f32 v[94:95], v[94:95], v[86:87]
    v_pk_fma_f32 v[20:21], v[20:21], v[54:55], v[54:55]
    v_pk_fma_f32 v[22:23], v[22:23], v[54:55], v[54:55]
    v_pk_fma_f32 v[24:25], v[24:25], v[54:55], v[54:55]
    v_pk_fma_f32 v[26:27], v[26:27], v[54:55], v[54:55]
    v_rcp_f32 v20, v20
    v_rcp_f32 v21, v21
    v_rcp_f32 v22, v22
    v_rcp_f32 v23, v23
    v_rcp_f32 v24, v24
    v_rcp_f32 v25, v25
    v_rcp_f32 v26, v26
    v_rcp_f32 v27, v27
    v_pk_mul_f32 v[88:89], v[88:89], v[20:21]
    v_pk_mul_f32 v[90:91], v[90:91], v[22:23]
    v_pk_mul_f32 v[92:93], v[92:93], v[24:25]
    v_pk_mul_f32 v[94:95], v[94:95], v[26:27]
    v_cvt_pk_bf16_f32 v32, v88, v89
    v_cvt_pk_bf16_f32 v33, v90, v91
    v_cvt_pk_bf16_f32 v34, v92, v93
    v_cvt_pk_bf16_f32 v35, v94, v95
    buffer_store_dwordx4 v[32:35], v12, s[56:59], s22 offen sc1
    s_add_u32 m0, s12, 0
    s_nop 0
    buffer_load_dwordx4 v40, s[52:55], s68 offen lds
    s_add_u32 m0, s12, 1024
    s_nop 0
    buffer_load_dwordx4 v41, s[52:55], s68 offen lds
    s_add_u32 s19, s19, 1
    s_cmp_eq_u32 s19, 14
    s_cselect_b32 s15, -13, 1
    s_mul_i32 s15, s15, 14336
    s_add_u32 s68, s68, s15
    s_lshr_b32 s6, s70, 1
    s_lshl_b32 s6, s6, 11
    s_add_u32 s6, s6, 10027008
    v_min_u32 v20, 13, v0
    v_lshl_add_u32 v20, v20, 7, s6
    s_cmp_eq_u32 s3, 0
    s_cselect_b32 s6, 32, 0
    v_mov_b32 v19, 2130706432
    v_mov_b32 v26, s78
    v_cmp_gt_u32 vcc, s6, v0
    s_nop 1
    v_cndmask_b32 v19, v19, v20, vcc
    v_cndmask_b32 v26, 0, v26, vcc
    s_waitcnt vmcnt(2)
    s_barrier
    buffer_store_dword v57, v62, s[56:59], s72 offen sc1
    s_add_u32 m0, s12, 49152
    s_nop 0
    buffer_load_dwordx4 v40, s[52:55], s68 offen lds
    s_add_u32 m0, s12, 50176
    s_nop 0
    buffer_load_dwordx4 v41, s[52:55], s68 offen lds
    s_add_u32 s19, s19, 1
    s_cmp_eq_u32 s19, 14
    s_cselect_b32 s15, -13, 1
    s_mul_i32 s15, s15, 14336
    s_add_u32 s68, s68, s15
    s_add_u32 m0, s12, 98304
    s_nop 0
    buffer_load_dwordx4 v40, s[52:55], s68 offen lds
    s_add_u32 m0, s12, 99328
    s_nop 0
    buffer_load_dwordx4 v41, s[52:55], s68 offen lds
    s_add_u32 s19, s19, 1
    s_cmp_eq_u32 s19, 14
    s_cselect_b32 s15, -13, 1
    s_mul_i32 s15, s15, 14336
    s_add_u32 s68, s68, s15
    s_waitcnt lgkmcnt(8)
    s_add_u32 m0, s12, 32768
    s_nop 0
    buffer_load_dwordx4 v40, s[52:55], s68 offen lds
    s_add_u32 m0, s12, 33792
    s_nop 0
    buffer_load_dwordx4 v41, s[52:55], s68 offen lds
    s_add_u32 s19, s19, 1
    s_cmp_eq_u32 s19, 14
    s_cselect_b32 s15, -13, 1
    s_mul_i32 s15, s15, 14336
    s_add_u32 s68, s68, s15
    s_waitcnt lgkmcnt(4)
    s_add_u32 m0, s12, 81920
    s_nop 0
    buffer_load_dwordx4 v40, s[52:55], s68 offen lds
    s_add_u32 m0, s12, 82944
    s_nop 0
    buffer_load_dwordx4 v41, s[52:55], s68 offen lds
    s_mov_b32 s60, s34
    s_and_b32 s61, s35, 0xffff
    s_mov_b32 s62, 1835008
    s_mov_b32 s63, 0x20000
    s_lshr_b32 s6, s3, 2
    s_lshl_b32 s6, s6, 5
    s_xor_b32 s73, s6, s25
    s_bfe_u32 s14, s3, 0x10001
    v_and_b32 v20, 31, v0
    v_lshrrev_b32 v21, 5, v0
    s_cmp_ge_u32 s71, 4
    s_cselect_b32 s69, 1, 0
    s_cselect_b64 vcc, -1, 0
    v_lshlrev_b32 v22, 6, v20
    v_add_u32 v22, s73, v22
    v_sub_u32 v23, 0x800, v22
    v_and_b32 v23, 0x7ff, v23
    v_cndmask_b32 v22, v22, v23, vcc
    v_lshrrev_b32 v22, 5, v22
    v_cvt_f32_u32 v31, v22
    v_cvt_f32_u32 v23, v21
    v_cvt_f32_u32 v22, s14
    v_mul_f32 v31, 0x3c800000, v31
    v_mul_f32 v22, 0xbe800000, v22
    v_mul_f32 v23, v23, v31
    v_fma_f32 v15, 2.0, v23, v22
    v_fma_f32 v24, -2.0, v23, v22
    v_fmamk_f32 v28, v31, 0x41800000, v22
    v_fmamk_f32 v28, v23, 0xc1900000, v28
    v_and_b32 v23, 15, v0
    v_lshlrev_b32 v22, 1, v21
    v_xor_b32 v22, v22, v23
    v_lshlrev_b32 v22, 4, v22
    v_lshl_or_b32 v22, v20, 8, v22
    s_lshl_b32 s11, s3, 14
    v_add_u32 v6, s11, v22
    s_and_b32 s7, s3, 1
    s_lshl_b32 s7, s7, 7
    v_xor_b32 v22, s7, v22
    s_lshr_b32 s7, s3, 2
    s_lshl1_add_u32 s7, s14, s7
    s_lshl_b32 s7, s7, 13
    s_add_u32 s7, s7, 131072
    v_add_u32 v7, s7, v22
    v_lshrrev_b32 v20, 3, v0
    v_lshl_add_u32 v20, s3, 3, v20
    v_and_b32 v21, 15, v20
    v_lshlrev_b32 v20, 8, v20
    v_and_b32 v22, 7, v0
    v_lshlrev_b32 v22, 1, v22
    v_xor_b32 v23, v22, v21
    v_lshl_add_u32 v8, v23, 4, v20
    v_xor_b32 v9, 16, v8
    v_add_u32 v10, 0x10000, v8
    v_add_u32 v11, 0x10000, v9
    v_add_u32 v20, 131072, v20
    v_sub_u32 v23, 14, v22
    v_cndmask_b32 v22, v22, v23, vcc
    v_add_u32 v23, 2, v22
    v_and_b32 v23, 15, v23
    v_xor_b32 v22, v22, v21
    v_xor_b32 v23, v23, v21
    v_lshl_add_u32 v12, v22, 4, v20
    v_xor_b32 v13, 16, v12
    v_lshl_add_u32 v14, v23, 4, v20
    buffer_load_dword v25, v19, s[56:59], 0 offen sc1
    ds_read_b64_tr_b16 v[232:233], v36 offset:16384
    ds_read_b64_tr_b16 v[234:235], v36 offset:16896
    ds_read_b64_tr_b16 v[236:237], v37 offset:16384
    ds_read_b64_tr_b16 v[238:239], v37 offset:16896
    ds_read_b64_tr_b16 v[240:241], v38 offset:16384
    ds_read_b64_tr_b16 v[242:243], v38 offset:16896
    ds_read_b64_tr_b16 v[244:245], v39 offset:16384
    ds_read_b64_tr_b16 v[246:247], v39 offset:16896
    ds_read_b64_tr_b16 v[248:249], v16 offset:16384
    ds_read_b64_tr_b16 v[250:251], v16 offset:16896
    ds_read_b64_tr_b16 v[252:253], v17 offset:16384
    ds_read_b64_tr_b16 v[254:255], v17 offset:16896
    s_waitcnt vmcnt(10)
    ds_read_b64_tr_b16 v[144:145], v36 offset:0
    ds_read_b64_tr_b16 v[146:147], v36 offset:512
    ds_read_b64_tr_b16 v[148:149], v37 offset:0
    ds_read_b64_tr_b16 v[150:151], v37 offset:512
    s_waitcnt vmcnt(7)
    ds_read_b64_tr_b16 v[152:153], v38 offset:0
    ds_read_b64_tr_b16 v[154:155], v38 offset:512
    ds_read_b64_tr_b16 v[156:157], v39 offset:0
    ds_read_b64_tr_b16 v[158:159], v39 offset:512
    s_waitcnt vmcnt(5)
    ds_read_b64_tr_b16 v[160:161], v16 offset:0
    ds_read_b64_tr_b16 v[162:163], v16 offset:512
    ds_read_b64_tr_b16 v[164:165], v17 offset:0
    ds_read_b64_tr_b16 v[166:167], v17 offset:512
    s_waitcnt vmcnt(3)
    ds_read_b64_tr_b16 v[168:169], v36 offset:32768
    ds_read_b64_tr_b16 v[170:171], v36 offset:33280
    ds_read_b64_tr_b16 v[172:173], v37 offset:32768
    ds_read_b64_tr_b16 v[174:175], v37 offset:33280
    s_waitcnt vmcnt(1)
    ds_read_b64_tr_b16 v[176:177], v38 offset:32768
    ds_read_b64_tr_b16 v[178:179], v38 offset:33280
    ds_read_b64_tr_b16 v[180:181], v39 offset:32768
    ds_read_b64_tr_b16 v[182:183], v39 offset:33280
    s_waitcnt vmcnt(0)
    v_cmp_ne_u32 vcc, v25, v26
    s_nop 1
    s_cbranch_vccz L_ok2
    s_mov_b32 s75, 0x10000
L_spin2:
    s_sleep 1
    buffer_load_dword v25, v19, s[56:59], 0 offen sc1
    s_waitcnt vmcnt(0)
    v_cmp_ne_u32 vcc, v25, v26
    s_nop 1
    s_cbranch_vccz L_ok2
    s_sub_u32 s75, s75, 1
    s_cmp_lg_u32 s75, 0
    s_cbranch_scc1 L_spin2
L_ok2:
    s_waitcnt lgkmcnt(0)
    s_barrier
    buffer_load_dwordx4 v[96:99], v1, s[56:59], s21 offen sc1
    s_sub_u32 s6, 64, s73
    s_sub_u32 s7, 6, s71
    s_cmp_lg_u32 s69, 0
    s_cselect_b32 s6, s6, s73
    s_cselect_b32 s7, s7, s71
    buffer_load_dwordx4 v[100:103], v1, s[56:59], s21 offen offset:1024 sc1
    s_and_b32 s6, s6, 31
    s_lshl1_add_u32 s6, s6, s14
    s_lshl_b32 s26, s6, 15
    buffer_load_dwordx4 v[104:107], v1, s[56:59], s21 offen offset:2048 sc1
    s_lshl_b32 s7, s7, 13
    s_add_u32 s26, s26, s7
    s_add_u32 s27, s26, 7348224
    buffer_load_dwordx4 v[108:111], v1, s[56:59], s21 offen offset:3072 sc1
    s_add_u32 s21, s21, 4096
    s_and_b32 s13, s3, 1
    s_lshl_b32 s6, s13, 12
    s_add_u32 s26, s26, s6
    buffer_load_dwordx4 v[112:115], v1, s[56:59], s21 offen sc1
    s_add_u32 s26, s26, 7340032
    s_add_u32 s11, s11, 8192
    s_andn2_b32 s6, s69, s13
    buffer_load_dwordx4 v[116:119], v1, s[56:59], s21 offen offset:1024 sc1
    s_cmp_lg_u32 s6, 0
    s_cselect_b32 s6, 0, 2130706432
    s_cselect_b32 s7, s11, 0x40000
    v_lshl_add_u32 v29, v0, 6, s6
    v_lshl_add_u32 v30, v0, 6, s7
    buffer_load_dwordx4 v[120:123], v1, s[56:59], s21 offen offset:2048 sc1
    v_lshrrev_b32 v20, 5, v0
    v_lshlrev_b32 v27, 9, v20
    v_bfe_u32 v20, v0, 2, 2
    buffer_load_dwordx4 v[124:127], v1, s[56:59], s21 offen offset:3072 sc1
    s_add_u32 s21, s21, 4096
    v_lshl_or_b32 v27, v20, 6, v27
    v_bfe_u32 v20, v0, 4, 1
    v_lshl_or_b32 v27, v20, 5, v27
    buffer_load_dwordx4 v[128:131], v1, s[56:59], s21 offen sc1
    v_and_b32 v20, 1, v0
    v_lshl_or_b32 v27, v20, 4, v27
    v_bfe_u32 v20, v0, 1, 1
    buffer_load_dwordx4 v[132:135], v1, s[56:59], s21 offen offset:1024 sc1
    v_lshl_or_b32 v27, v20, 3, v27
    v_add_u32 v27, s11, v27
    buffer_load_dwordx4 v[136:139], v1, s[56:59], s21 offen offset:2048 sc1
    buffer_load_dwordx4 v[140:143], v1, s[56:59], s21 offen offset:3072 sc1
    s_add_u32 s21, s21, 4096
    buffer_load_dwordx4 v[64:67], v1, s[56:59], s21 offen sc1
    buffer_load_dwordx4 v[68:71], v1, s[56:59], s21 offen offset:1024 sc1
    s_add_u32 s21, s21, 102400
    v_mov_b32 v19, 0
    v_mov_b32 v26, 32
    s_waitcnt vmcnt(13)
    v_mfma_f32_32x32x16_bf16 v[48:63], v[188:191], v[96:99], 0
    v_mfma_f32_32x32x16_bf16 v[32:47], v[184:187], v[96:99], 0
    s_waitcnt vmcnt(12)
    v_mfma_f32_32x32x16_bf16 v[32:47], v[192:195], v[100:103], v[32:47]
    v_mfma_f32_32x32x16_bf16 v[48:63], v[196:199], v[100:103], v[48:63]
    s_waitcnt vmcnt(11)
    v_mfma_f32_32x32x16_bf16 v[48:63], v[204:207], v[104:107], v[48:63]
    v_mfma_f32_32x32x16_bf16 v[32:47], v[200:203], v[104:107], v[32:47]
    s_waitcnt vmcnt(10)
    v_mfma_f32_32x32x16_bf16 v[32:47], v[208:211], v[108:111], v[32:47]
    v_mfma_f32_32x32x16_bf16 v[48:63], v[212:215], v[108:111], v[48:63]
    s_waitcnt vmcnt(9)
    v_mfma_f32_32x32x16_bf16 v[48:63], v[220:223], v[112:115], v[48:63]
    v_mfma_f32_32x32x16_bf16 v[32:47], v[216:219], v[112:115], v[32:47]
    s_waitcnt vmcnt(8)
    v_mfma_f32_32x32x16_bf16 v[32:47], v[224:227], v[116:119], v[32:47]
    v_mfma_f32_32x32x16_bf16 v[48:63], v[228:231], v[116:119], v[48:63]
    s_waitcnt vmcnt(7)
    v_mfma_f32_32x32x16_bf16 v[48:63], v[236:239], v[120:123], v[48:63]
    v_mfma_f32_32x32x16_bf16 v[32:47], v[232:235], v[120:123], v[32:47]
    s_waitcnt vmcnt(6)
    v_mfma_f32_32x32x16_bf16 v[32:47], v[240:243], v[124:127], v[32:47]
    v_mfma_f32_32x32x16_bf16 v[48:63], v[244:247], v[124:127], v[48:63]
    s_waitcnt vmcnt(5)
    v_mfma_f32_32x32x16_bf16 v[48:63], v[252:255], v[128:131], v[48:63]
    v_mfma_f32_32x32x16_bf16 v[32:47], v[248:251], v[128:131], v[32:47]
    s_waitcnt vmcnt(4)
    v_mfma_f32_32x32x16_bf16 v[32:47], v[144:147], v[132:135], v[32:47]
    v_mfma_f32_32x32x16_bf16 v[48:63], v[148:151], v[132:135], v[48:63]
    s_waitcnt vmcnt(3)
    v_mfma_f32_32x32x16_bf16 v[48:63], v[156:159], v[136:139], v[48:63]
    v_mfma_f32_32x32x16_bf16 v[32:47], v[152:155], v[136:139], v[32:47]
    s_waitcnt vmcnt(2)
    v_mfma_f32_32x32x16_bf16 v[32:47], v[160:163], v[140:143], v[32:47]
    v_mfma_f32_32x32x16_bf16 v[48:63], v[164:167], v[140:143], v[48:63]
    buffer_load_dword v25, v19, s[64:67], 0 offen offset:128 sc1
    s_waitcnt vmcnt(2)
    v_mfma_f32_32x32x16_bf16 v[48:63], v[172:175], v[64:67], v[48:63]
    v_mfma_f32_32x32x16_bf16 v[32:47], v[168:171], v[64:67], v[32:47]
    s_waitcnt vmcnt(1)
    v_mfma_f32_32x32x16_bf16 v[32:47], v[176:179], v[68:71], v[32:47]
    v_mfma_f32_32x32x16_bf16 v[48:63], v[180:183], v[68:71], v[48:63]
    buffer_load_dwordx4 v[96:99], v1, s[56:59], s21 offen sc1
    s_nop 9
    ds_write_b128 v6, v[32:35] offset:0
    v_xor_b32 v16, 16, v6
    ds_write_b128 v16, v[36:39] offset:0
    v_xor_b32 v16, 64, v6
    buffer_load_dwordx4 v[100:103], v1, s[56:59], s21 offen offset:1024 sc1
    ds_write_b128 v16, v[40:43] offset:0
    v_xor_b32 v16, 80, v6
    ds_write_b128 v16, v[44:47] offset:0
    v_xor_b32 v16, 128, v6
    buffer_load_dwordx4 v[104:107], v1, s[56:59], s21 offen offset:2048 sc1
    ds_write_b128 v16, v[48:51] offset:0
    v_xor_b32 v16, 144, v6
    ds_write_b128 v16, v[52:55] offset:0
    v_xor_b32 v16, 192, v6
    buffer_load_dwordx4 v[108:111], v1, s[56:59], s21 offen offset:3072 sc1
    s_add_u32 s21, s21, 4096
    ds_write_b128 v16, v[56:59] offset:0
    v_xor_b32 v16, 208, v6
    ds_write_b128 v16, v[60:63] offset:0
    v_cos_f32 v22, v15
    buffer_load_dwordx4 v[112:115], v1, s[56:59], s21 offen sc1
    v_fmamk_f32 v21, v31, 0x42000000, v15
    v_cos_f32 v23, v21
    s_nop 0
    v_cvt_pk_bf16_f32 v32, v22, v23
    v_cos_f32 v22, v28
    buffer_load_dwordx4 v[116:119], v1, s[56:59], s21 offen offset:1024 sc1
    v_fmamk_f32 v21, v31, 0x42000000, v28
    v_cos_f32 v23, v21
    s_nop 0
    v_cvt_pk_bf16_f32 v33, v22, v23
    v_fmamk_f32 v20, v31, 0x3f800000, v15
    buffer_load_dwordx4 v[120:123], v1, s[56:59], s21 offen offset:2048 sc1
    v_cos_f32 v22, v20
    v_fmamk_f32 v21, v31, 0x42040000, v15
    v_cos_f32 v23, v21
    s_nop 0
    v_cvt_pk_bf16_f32 v34, v22, v23
    buffer_load_dwordx4 v[124:127], v1, s[56:59], s21 offen offset:3072 sc1
    s_add_u32 s21, s21, 4096
    v_fmamk_f32 v20, v31, 0xbf800000, v24
    v_cos_f32 v22, v20
    v_fmamk_f32 v21, v31, 0x41f80000, v24
    v_cos_f32 v23, v21
    buffer_load_dwordx4 v[128:131], v1, s[56:59], s21 offen sc1
    v_cvt_pk_bf16_f32 v35, v22, v23
    v_fmamk_f32 v20, v31, 0x40800000, v15
    v_cos_f32 v22, v20
    v_fmamk_f32 v21, v31, 0x42100000, v15
    buffer_load_dwordx4 v[132:135], v1, s[56:59], s21 offen offset:1024 sc1
    v_cos_f32 v23, v21
    s_nop 0
    v_cvt_pk_bf16_f32 v36, v22, v23
    v_fmamk_f32 v20, v31, 0xc0800000, v24
    v_cos_f32 v22, v20
    buffer_load_dwordx4 v[136:139], v1, s[56:59], s21 offen offset:2048 sc1
    v_fmamk_f32 v21, v31, 0x41e00000, v24
    v_cos_f32 v23, v21
    s_nop 0
    v_cvt_pk_bf16_f32 v37, v22, v23
    v_fmamk_f32 v20, v31, 0x40a00000, v15
    buffer_load_dwordx4 v[140:143], v1, s[56:59], s21 offen offset:3072 sc1
    s_add_u32 s21, s21, 4096
    v_cos_f32 v22, v20
    v_fmamk_f32 v21, v31, 0x42140000, v15
    v_cos_f32 v23, v21
    s_nop 0
    v_cvt_pk_bf16_f32 v38, v22, v23
    buffer_load_dwordx4 v[48:51], v1, s[56:59], s21 offen sc1
    v_fmamk_f32 v20, v31, 0xc0a00000, v24
    v_cos_f32 v22, v20
    v_fmamk_f32 v21, v31, 0x41d80000, v24
    v_cos_f32 v23, v21
    buffer_load_dwordx4 v[52:55], v1, s[56:59], s21 offen offset:1024 sc1
    v_cvt_pk_bf16_f32 v39, v22, v23
    v_fmamk_f32 v20, v31, 0x41000000, v15
    v_cos_f32 v22, v20
    s_cmp_ge_u32 s3, 4
    s_cbranch_scc1 L_g1
    s_waitcnt vmcnt(13)
    v_mfma_f32_32x32x16_bf16 v[80:95], v[188:191], v[96:99], 0
    v_mfma_f32_32x32x16_bf16 v[64:79], v[184:187], v[96:99], 0
    v_cmp_lt_u32 vcc, v25, v26
    s_nop 1
    s_cbranch_vccz L_ok3
    s_mov_b32 s75, 0x10000
L_spin3:
    s_sleep 4
    buffer_load_dword v25, v19, s[64:67], 0 offen offset:128 sc1
    s_waitcnt vmcnt(0)
    v_cmp_lt_u32 vcc, v25, v26
    s_nop 1
    s_cbranch_vccz L_ok3
    s_sub_u32 s75, s75, 1
    s_cmp_lg_u32 s75, 0
    s_cbranch_scc1 L_spin3
L_ok3:
    s_add_u32 m0, s11, 0
    s_nop 0
    buffer_load_dwordx4 v1, s[56:59], s26 offen sc1 lds
    s_add_u32 m0, s11, 0
    s_nop 0
    buffer_load_dwordx4 v1, s[56:59], s26 offen offset:1024 sc1 lds
    s_add_u32 m0, s11, 0
    s_nop 0
    buffer_load_dwordx4 v1, s[56:59], s26 offen offset:2048 sc1 lds
    s_add_u32 m0, s11, 0
    s_nop 0
    buffer_load_dwordx4 v1, s[56:59], s26 offen offset:3072 sc1 lds
    buffer_load_ushort v17, v29, s[56:59], s27 offen sc1
    v_fmamk_f32 v21, v31, 0x42200000, v15
    v_cos_f32 v23, v21
    s_nop 0
    v_cvt_pk_bf16_f32 v40, v22, v23
    v_fmamk_f32 v20, v31, 0xc1000000, v24
    v_cos_f32 v22, v20
    v_fmamk_f32 v21, v31, 0x41c00000, v24
    s_waitcnt vmcnt(17)
    v_mfma_f32_32x32x16_bf16 v[64:79], v[192:195], v[100:103], v[64:79]
    v_mfma_f32_32x32x16_bf16 v[80:95], v[196:199], v[100:103], v[80:95]
    v_cos_f32 v23, v21
    s_nop 0
    v_cvt_pk_bf16_f32 v41, v22, v23
    v_fmamk_f32 v20, v31, 0x41100000, v15
    v_cos_f32 v22, v20
    v_fmamk_f32 v21, v31, 0x42240000, v15
    v_cos_f32 v23, v21
    s_waitcnt vmcnt(16)
    v_mfma_f32_32x32x16_bf16 v[80:95], v[204:207], v[104:107], v[80:95]
    v_mfma_f32_32x32x16_bf16 v[64:79], v[200:203], v[104:107], v[64:79]
    v_cvt_pk_bf16_f32 v42, v22, v23
    v_fmamk_f32 v20, v31, 0xc1100000, v24
    v_cos_f32 v22, v20
    v_fmamk_f32 v21, v31, 0x41b80000, v24
    v_cos_f32 v23, v21
    s_nop 0
    v_cvt_pk_bf16_f32 v43, v22, v23
    s_waitcnt vmcnt(15)
    v_mfma_f32_32x32x16_bf16 v[64:79], v[208:211], v[108:111], v[64:79]
    v_mfma_f32_32x32x16_bf16 v[80:95], v[212:215], v[108:111], v[80:95]
    v_fmamk_f32 v20, v31, 0x41400000, v15
    v_cos_f32 v22, v20
    v_fmamk_f32 v21, v31, 0x42300000, v15
    v_cos_f32 v23, v21
    s_nop 0
    v_cvt_pk_bf16_f32 v44, v22, v23
    v_fmamk_f32 v20, v31, 0xc1400000, v24
    s_waitcnt vmcnt(14)
    v_mfma_f32_32x32x16_bf16 v[80:95], v[220:223], v[112:115], v[80:95]
    v_mfma_f32_32x32x16_bf16 v[64:79], v[216:219], v[112:115], v[64:79]
    v_cos_f32 v22, v20
    v_fmamk_f32 v21, v31, 0x41a00000, v24
    v_cos_f32 v23, v21
    s_nop 0
    v_cvt_pk_bf16_f32 v45, v22, v23
    v_fmamk_f32 v20, v31, 0x41500000, v15
    v_cos_f32 v22, v20
    s_waitcnt vmcnt(13)
    v_mfma_f32_32x32x16_bf16 v[64:79], v[224:227], v[116:119], v[64:79]
    v_mfma_f32_32x32x16_bf16 v[80:95], v[228:231], v[116:119], v[80:95]
    v_fmamk_f32 v21, v31, 0x42340000, v15
    v_cos_f32 v23, v21
    s_nop 0
    v_cvt_pk_bf16_f32 v46, v22, v23
    v_fmamk_f32 v20, v31, 0xc1500000, v24
    v_cos_f32 v22, v20
    v_fmamk_f32 v21, v31, 0x41980000, v24
    s_waitcnt vmcnt(12)
    v_mfma_f32_32x32x16_bf16 v[80:95], v[236:239], v[120:123], v[80:95]
    v_mfma_f32_32x32x16_bf16 v[64:79], v[232:235], v[120:123], v[64:79]
    v_cos_f32 v23, v21
    s_nop 0
    v_cvt_pk_bf16_f32 v47, v22, v23
    s_waitcnt vmcnt(11)
    v_mfma_f32_32x32x16_bf16 v[64:79], v[240:243], v[124:127], v[64:79]
    v_mfma_f32_32x32x16_bf16 v[80:95], v[244:247], v[124:127], v[80:95]
    s_waitcnt vmcnt(10)
    v_mfma_f32_32x32x16_bf16 v[80:95], v[252:255], v[128:131], v[80:95]
    v_mfma_f32_32x32x16_bf16 v[64:79], v[248:251], v[128:131], v[64:79]
    s_waitcnt vmcnt(9)
    v_mfma_f32_32x32x16_bf16 v[64:79], v[144:147], v[132:135], v[64:79]
    v_mfma_f32_32x32x16_bf16 v[80:95], v[148:151], v[132:135], v[80:95]
    s_waitcnt vmcnt(8)
    v_mfma_f32_32x32x16_bf16 v[80:95], v[156:159], v[136:139], v[80:95]
    v_mfma_f32_32x32x16_bf16 v[64:79], v[152:155], v[136:139], v[64:79]
    s_waitcnt vmcnt(7)
    v_mfma_f32_32x32x16_bf16 v[64:79], v[160:163], v[140:143], v[64:79]
    v_mfma_f32_32x32x16_bf16 v[80:95], v[164:167], v[140:143], v[80:95]
    s_waitcnt vmcnt(6)
    v_mfma_f32_32x32x16_bf16 v[80:95], v[172:175], v[48:51], v[80:95]
    v_mfma_f32_32x32x16_bf16 v[64:79], v[168:171], v[48:51], v[64:79]
    s_waitcnt vmcnt(5)
    v_mfma_f32_32x32x16_bf16 v[64:79], v[176:179], v[52:55], v[64:79]
    v_mfma_f32_32x32x16_bf16 v[80:95], v[180:183], v[52:55], v[80:95]
    s_waitcnt vmcnt(0)
    ds_write_b16 v30, v17
    ds_read_b64_tr_b16 v[184:185], v27 offset:0
    ds_read_b64_tr_b16 v[186:187], v27 offset:256
    ds_read_b64_tr_b16 v[188:189], v27 offset:1024
    ds_read_b64_tr_b16 v[190:191], v27 offset:1280
    ds_read_b64_tr_b16 v[192:193], v27 offset:2048
    ds_read_b64_tr_b16 v[194:195], v27 offset:2304
    ds_read_b64_tr_b16 v[196:197], v27 offset:3072
    ds_read_b64_tr_b16 v[198:199], v27 offset:3328
    s_waitcnt lgkmcnt(0)
    v_mfma_f32_32x32x16_bf16 v[48:63], v[184:187], v[32:35], 0
    v_mfma_f32_32x32x16_bf16 v[48:63], v[188:191], v[36:39], v[48:63]
    v_mfma_f32_32x32x16_bf16 v[48:63], v[192:195], v[40:43], v[48:63]
    v_mfma_f32_32x32x16_bf16 v[48:63], v[196:199], v[44:47], v[48:63]
    ds_write_b128 v6, v[64:67] offset:8192
    v_xor_b32 v16, 16, v6
    ds_write_b128 v16, v[68:71] offset:8192
    v_xor_b32 v16, 64, v6
    ds_write_b128 v16, v[72:75] offset:8192
    v_xor_b32 v16, 80, v6
    ds_write_b128 v16, v[76:79] offset:8192
    v_xor_b32 v16, 128, v6
    ds_write_b128 v16, v[80:83] offset:8192
    v_xor_b32 v16, 144, v6
    ds_write_b128 v16, v[84:87] offset:8192
    v_xor_b32 v16, 192, v6
    ds_write_b128 v16, v[88:91] offset:8192
    v_xor_b32 v16, 208, v6
    ds_write_b128 v16, v[92:95] offset:8192
    ds_write_b128 v7, v[48:51]
    v_xor_b32 v24, 16, v7
    ds_write_b128 v24, v[52:55]
    v_xor_b32 v24, 64, v7
    ds_write_b128 v24, v[56:59]
    v_xor_b32 v24, 80, v7
    ds_write_b128 v24, v[60:63]
    v_lshlrev_b32 v96, 16, v2
    v_and_b32 v97, 0xffff0000, v2
    v_lshlrev_b32 v98, 16, v3
    v_and_b32 v99, 0xffff0000, v3
    v_lshlrev_b32 v100, 16, v4
    v_and_b32 v101, 0xffff0000, v4
    v_lshlrev_b32 v102, 16, v5
    v_and_b32 v103, 0xffff0000, v5
    s_mov_b32 s14, 0xbfb8aa3b
    s_mov_b32 s15, s14
    s_mov_b32 s6, 1.0
    s_mov_b32 s7, 1.0
    s_waitcnt lgkmcnt(0)
    s_barrier
    ds_read_b128 v[128:131], v8 offset:0
    ds_read_b128 v[132:135], v9 offset:0
    ds_read_b128 v[136:139], v8 offset:16384
    ds_read_b128 v[140:143], v9 offset:16384
    ds_read_b128 v[144:147], v8 offset:32768
    ds_read_b128 v[148:151], v9 offset:32768
    ds_read_b128 v[152:155], v8 offset:49152
    ds_read_b128 v[156:159], v9 offset:49152
    ds_read_b128 v[160:163], v10 offset:0
    ds_read_b128 v[164:167], v11 offset:0
    ds_read_b128 v[168:171], v10 offset:16384
    ds_read_b128 v[172:175], v11 offset:16384
    ds_read_b128 v[176:179], v10 offset:32768
    ds_read_b128 v[180:183], v11 offset:32768
    ds_read_b128 v[184:187], v10 offset:49152
    ds_read_b128 v[188:191], v11 offset:49152
    ds_read_b128 v[104:107], v12 offset:0
    ds_read_b128 v[108:111], v13 offset:0
    ds_read_b32 v112, v14 offset:0
    ds_read_b128 v[114:117], v12 offset:16384
    ds_read_b128 v[118:121], v13 offset:16384
    ds_read_b32 v122, v14 offset:16384
    s_waitcnt lgkmcnt(15)
    v_pk_add_f32 v[128:129], v[128:129], v[136:137]
    v_pk_add_f32 v[130:131], v[130:131], v[138:139]
    v_pk_add_f32 v[132:133], v[132:133], v[140:141]
    v_pk_add_f32 v[134:135], v[134:135], v[142:143]
    v_pk_add_f32 v[128:129], v[128:129], v[144:145]
    v_pk_add_f32 v[130:131], v[130:131], v[146:147]
    v_pk_add_f32 v[132:133], v[132:133], v[148:149]
    v_pk_add_f32 v[134:135], v[134:135], v[150:151]
    s_waitcnt lgkmcnt(14)
    v_pk_add_f32 v[128:129], v[128:129], v[152:153]
    v_pk_add_f32 v[130:131], v[130:131], v[154:155]
    v_pk_add_f32 v[132:133], v[132:133], v[156:157]
    v_pk_add_f32 v[134:135], v[134:135], v[158:159]
    s_waitcnt lgkmcnt(12)
    v_pk_add_f32 v[128:129], v[128:129], v[160:161]
    v_pk_add_f32 v[130:131], v[130:131], v[162:163]
    v_pk_add_f32 v[132:133], v[132:133], v[164:165]
    v_pk_add_f32 v[134:135], v[134:135], v[166:167]
    s_waitcnt lgkmcnt(10)
    v_pk_add_f32 v[128:129], v[128:129], v[168:169]
    v_pk_add_f32 v[130:131], v[130:131], v[170:171]
    v_pk_add_f32 v[132:133], v[132:133], v[172:173]
    v_pk_add_f32 v[134:135], v[134:135], v[174:175]
    s_waitcnt lgkmcnt(8)
    v_pk_add_f32 v[128:129], v[128:129], v[176:177]
    v_pk_add_f32 v[130:131], v[130:131], v[178:179]
    v_pk_add_f32 v[132:133], v[132:133], v[180:181]
    v_pk_add_f32 v[134:135], v[134:135], v[182:183]
    s_waitcnt lgkmcnt(6)
    v_pk_add_f32 v[128:129], v[128:129], v[184:185]
    v_pk_add_f32 v[130:131], v[130:131], v[186:187]
    v_pk_add_f32 v[132:133], v[132:133], v[188:189]
    v_pk_add_f32 v[134:135], v[134:135], v[190:191]
    v_pk_mul_f32 v[200:201], v[128:129], s[14:15]
    v_pk_mul_f32 v[202:203], v[130:131], s[14:15]
    v_pk_mul_f32 v[204:205], v[132:133], s[14:15]
    v_pk_mul_f32 v[206:207], v[134:135], s[14:15]
    v_exp_f32 v200, v200
    v_exp_f32 v201, v201
    v_exp_f32 v202, v202
    v_exp_f32 v203, v203
    v_exp_f32 v204, v204
    v_exp_f32 v205, v205
    v_exp_f32 v206, v206
    v_exp_f32 v207, v207
    s_waitcnt lgkmcnt(0)
    s_cmp_lg_u32 s69, 0
    s_cbranch_scc1 L_mir0
    v_add_f32 v192, v104, v114
    v_add_f32 v193, v105, v115
    v_add_f32 v194, v106, v116
    v_add_f32 v195, v107, v117
    v_add_f32 v196, v108, v118
    v_add_f32 v197, v109, v119
    v_add_f32 v198, v110, v120
    v_add_f32 v199, v111, v121
    s_branch L_mirj0
L_mir0:
    v_add_f32 v192, v112, v122
    v_add_f32 v193, v111, v121
    v_add_f32 v194, v110, v120
    v_add_f32 v195, v109, v119
    v_add_f32 v196, v108, v118
    v_add_f32 v197, v107, v117
    v_add_f32 v198, v106, v116
    v_add_f32 v199, v105, v115
L_mirj0:
    v_pk_add_f32 v[200:201], v[200:201], s[6:7]
    v_pk_add_f32 v[202:203], v[202:203], s[6:7]
    v_pk_add_f32 v[204:205], v[204:205], s[6:7]
    v_pk_add_f32 v[206:207], v[206:207], s[6:7]
    v_rcp_f32 v200, v200
    v_rcp_f32 v201, v201
    v_rcp_f32 v202, v202
    v_rcp_f32 v203, v203
    v_rcp_f32 v204, v204
    v_rcp_f32 v205, v205
    v_rcp_f32 v206, v206
    v_rcp_f32 v207, v207
    v_pk_mul_f32 v[192:193], v[192:193], v[128:129]
    v_pk_mul_f32 v[194:195], v[194:195], v[130:131]
    v_pk_mul_f32 v[196:197], v[196:197], v[132:133]
    v_pk_mul_f32 v[198:199], v[198:199], v[134:135]
    v_pk_fma_f32 v[96:97], v[192:193], v[200:201], v[96:97]
    v_pk_fma_f32 v[98:99], v[194:195], v[202:203], v[98:99]
    v_pk_fma_f32 v[100:101], v[196:197], v[204:205], v[100:101]
    v_pk_fma_f32 v[102:103], v[198:199], v[206:207], v[102:103]
    v_cvt_pk_bf16_f32 v200, v96, v97
    v_cvt_pk_bf16_f32 v201, v98, v99
    v_cvt_pk_bf16_f32 v202, v100, v101
    v_cvt_pk_bf16_f32 v203, v102, v103
    buffer_store_dwordx4 v[200:203], v18, s[60:63], s74 offen nt
    s_barrier
    s_endpgm
.p2align 3
L_g1:
    s_waitcnt vmcnt(13)
    v_mfma_f32_32x32x16_bf16 v[80:95], v[188:191], v[96:99], 0
    v_mfma_f32_32x32x16_bf16 v[64:79], v[184:187], v[96:99], 0
    v_cmp_lt_u32 vcc, v25, v26
    s_nop 1
    s_cbranch_vccz L_ok4
    s_mov_b32 s75, 0x10000
L_spin4:
    s_sleep 4
    buffer_load_dword v25, v19, s[64:67], 0 offen offset:128 sc1
    s_waitcnt vmcnt(0)
    v_cmp_lt_u32 vcc, v25, v26
    s_nop 1
    s_cbranch_vccz L_ok4
    s_sub_u32 s75, s75, 1
    s_cmp_lg_u32 s75, 0
    s_cbranch_scc1 L_spin4
L_ok4:
    s_add_u32 m0, s11, 0
    s_nop 0
    buffer_load_dwordx4 v1, s[56:59], s26 offen sc1 lds
    s_add_u32 m0, s11, 0
    s_nop 0
    buffer_load_dwordx4 v1, s[56:59], s26 offen offset:1024 sc1 lds
    s_add_u32 m0, s11, 0
    s_nop 0
    buffer_load_dwordx4 v1, s[56:59], s26 offen offset:2048 sc1 lds
    s_add_u32 m0, s11, 0
    s_nop 0
    buffer_load_dwordx4 v1, s[56:59], s26 offen offset:3072 sc1 lds
    buffer_load_ushort v17, v29, s[56:59], s27 offen sc1
    v_fmamk_f32 v21, v31, 0x42200000, v15
    v_cos_f32 v23, v21
    s_nop 0
    v_cvt_pk_bf16_f32 v40, v22, v23
    v_fmamk_f32 v20, v31, 0xc1000000, v24
    v_cos_f32 v22, v20
    v_fmamk_f32 v21, v31, 0x41c00000, v24
    s_waitcnt vmcnt(17)
    v_mfma_f32_32x32x16_bf16 v[64:79], v[192:195], v[100:103], v[64:79]
    v_mfma_f32_32x32x16_bf16 v[80:95], v[196:199], v[100:103], v[80:95]
    v_cos_f32 v23, v21
    s_nop 0
    v_cvt_pk_bf16_f32 v41, v22, v23
    v_fmamk_f32 v20, v31, 0x41100000, v15
    v_cos_f32 v22, v20
    v_fmamk_f32 v21, v31, 0x42240000, v15
    v_cos_f32 v23, v21
    s_waitcnt vmcnt(16)
    v_mfma_f32_32x32x16_bf16 v[80:95], v[204:207], v[104:107], v[80:95]
    v_mfma_f32_32x32x16_bf16 v[64:79], v[200:203], v[104:107], v[64:79]
    v_cvt_pk_bf16_f32 v42, v22, v23
    v_fmamk_f32 v20, v31, 0xc1100000, v24
    v_cos_f32 v22, v20
    v_fmamk_f32 v21, v31, 0x41b80000, v24
    v_cos_f32 v23, v21
    s_nop 0
    v_cvt_pk_bf16_f32 v43, v22, v23
    s_waitcnt vmcnt(15)
    v_mfma_f32_32x32x16_bf16 v[64:79], v[208:211], v[108:111], v[64:79]
    v_mfma_f32_32x32x16_bf16 v[80:95], v[212:215], v[108:111], v[80:95]
    v_fmamk_f32 v20, v31, 0x41400000, v15
    v_cos_f32 v22, v20
    v_fmamk_f32 v21, v31, 0x42300000, v15
    v_cos_f32 v23, v21
    s_nop 0
    v_cvt_pk_bf16_f32 v44, v22, v23
    v_fmamk_f32 v20, v31, 0xc1400000, v24
    s_waitcnt vmcnt(14)
    v_mfma_f32_32x32x16_bf16 v[80:95], v[220:223], v[112:115], v[80:95]
    v_mfma_f32_32x32x16_bf16 v[64:79], v[216:219], v[112:115], v[64:79]
    v_cos_f32 v22, v20
    v_fmamk_f32 v21, v31, 0x41a00000, v24
    v_cos_f32 v23, v21
    s_nop 0
    v_cvt_pk_bf16_f32 v45, v22, v23
    v_fmamk_f32 v20, v31, 0x41500000, v15
    v_cos_f32 v22, v20
    s_waitcnt vmcnt(13)
    v_mfma_f32_32x32x16_bf16 v[64:79], v[224:227], v[116:119], v[64:79]
    v_mfma_f32_32x32x16_bf16 v[80:95], v[228:231], v[116:119], v[80:95]
    v_fmamk_f32 v21, v31, 0x42340000, v15
    v_cos_f32 v23, v21
    s_nop 0
    v_cvt_pk_bf16_f32 v46, v22, v23
    v_fmamk_f32 v20, v31, 0xc1500000, v24
    v_cos_f32 v22, v20
    v_fmamk_f32 v21, v31, 0x41980000, v24
    s_waitcnt vmcnt(12)
    v_mfma_f32_32x32x16_bf16 v[80:95], v[236:239], v[120:123], v[80:95]
    v_mfma_f32_32x32x16_bf16 v[64:79], v[232:235], v[120:123], v[64:79]
    v_cos_f32 v23, v21
    s_nop 0
    v_cvt_pk_bf16_f32 v47, v22, v23
    s_waitcnt vmcnt(11)
    v_mfma_f32_32x32x16_bf16 v[64:79], v[240:243], v[124:127], v[64:79]
    v_mfma_f32_32x32x16_bf16 v[80:95], v[244:247], v[124:127], v[80:95]
    s_waitcnt vmcnt(10)
    v_mfma_f32_32x32x16_bf16 v[80:95], v[252:255], v[128:131], v[80:95]
    v_mfma_f32_32x32x16_bf16 v[64:79], v[248:251], v[128:131], v[64:79]
    s_waitcnt vmcnt(9)
    v_mfma_f32_32x32x16_bf16 v[64:79], v[144:147], v[132:135], v[64:79]
    v_mfma_f32_32x32x16_bf16 v[80:95], v[148:151], v[132:135], v[80:95]
    s_waitcnt lgkmcnt(0)
    s_barrier
    s_waitcnt vmcnt(8)
    v_mfma_f32_32x32x16_bf16 v[80:95], v[156:159], v[136:139], v[80:95]
    v_mfma_f32_32x32x16_bf16 v[64:79], v[152:155], v[136:139], v[64:79]
    s_waitcnt vmcnt(7)
    v_mfma_f32_32x32x16_bf16 v[64:79], v[160:163], v[140:143], v[64:79]
    v_mfma_f32_32x32x16_bf16 v[80:95], v[164:167], v[140:143], v[80:95]
    s_waitcnt vmcnt(6)
    v_mfma_f32_32x32x16_bf16 v[80:95], v[172:175], v[48:51], v[80:95]
    v_mfma_f32_32x32x16_bf16 v[64:79], v[168:171], v[48:51], v[64:79]
    s_waitcnt vmcnt(5)
    v_mfma_f32_32x32x16_bf16 v[64:79], v[176:179], v[52:55], v[64:79]
    v_mfma_f32_32x32x16_bf16 v[80:95], v[180:183], v[52:55], v[80:95]
    s_waitcnt vmcnt(0)
    ds_write_b16 v30, v17
    ds_read_b64_tr_b16 v[184:185], v27 offset:0
    ds_read_b64_tr_b16 v[186:187], v27 offset:256
    ds_read_b64_tr_b16 v[188:189], v27 offset:1024
    ds_read_b64_tr_b16 v[190:191], v27 offset:1280
    ds_read_b64_tr_b16 v[192:193], v27 offset:2048
    ds_read_b64_tr_b16 v[194:195], v27 offset:2304
    ds_read_b64_tr_b16 v[196:197], v27 offset:3072
    ds_read_b64_tr_b16 v[198:199], v27 offset:3328
    s_waitcnt lgkmcnt(0)
    v_mfma_f32_32x32x16_bf16 v[48:63], v[184:187], v[32:35], 0
    v_mfma_f32_32x32x16_bf16 v[48:63], v[188:191], v[36:39], v[48:63]
    v_mfma_f32_32x32x16_bf16 v[48:63], v[192:195], v[40:43], v[48:63]
    v_mfma_f32_32x32x16_bf16 v[48:63], v[196:199], v[44:47], v[48:63]
    ds_write_b128 v6, v[64:67] offset:8192
    v_xor_b32 v16, 16, v6
    ds_write_b128 v16, v[68:71] offset:8192
    v_xor_b32 v16, 64, v6
    ds_write_b128 v16, v[72:75] offset:8192
    v_xor_b32 v16, 80, v6
    ds_write_b128 v16, v[76:79] offset:8192
    v_xor_b32 v16, 128, v6
    ds_write_b128 v16, v[80:83] offset:8192
    v_xor_b32 v16, 144, v6
    ds_write_b128 v16, v[84:87] offset:8192
    v_xor_b32 v16, 192, v6
    ds_write_b128 v16, v[88:91] offset:8192
    v_xor_b32 v16, 208, v6
    ds_write_b128 v16, v[92:95] offset:8192
    ds_write_b128 v7, v[48:51]
    v_xor_b32 v24, 16, v7
    ds_write_b128 v24, v[52:55]
    v_xor_b32 v24, 64, v7
    ds_write_b128 v24, v[56:59]
    v_xor_b32 v24, 80, v7
    ds_write_b128 v24, v[60:63]
    v_lshlrev_b32 v96, 16, v2
    v_and_b32 v97, 0xffff0000, v2
    v_lshlrev_b32 v98, 16, v3
    v_and_b32 v99, 0xffff0000, v3
    v_lshlrev_b32 v100, 16, v4
    v_and_b32 v101, 0xffff0000, v4
    v_lshlrev_b32 v102, 16, v5
    v_and_b32 v103, 0xffff0000, v5
    s_mov_b32 s14, 0xbfb8aa3b
    s_mov_b32 s15, s14
    s_mov_b32 s6, 1.0
    s_mov_b32 s7, 1.0
    s_waitcnt lgkmcnt(0)
    s_barrier
    ds_read_b128 v[128:131], v8 offset:0
    ds_read_b128 v[132:135], v9 offset:0
    ds_read_b128 v[136:139], v8 offset:16384
    ds_read_b128 v[140:143], v9 offset:16384
    ds_read_b128 v[144:147], v8 offset:32768
    ds_read_b128 v[148:151], v9 offset:32768
    ds_read_b128 v[152:155], v8 offset:49152
    ds_read_b128 v[156:159], v9 offset:49152
    ds_read_b128 v[160:163], v10 offset:0
    ds_read_b128 v[164:167], v11 offset:0
    ds_read_b128 v[168:171], v10 offset:16384
    ds_read_b128 v[172:175], v11 offset:16384
    ds_read_b128 v[176:179], v10 offset:32768
    ds_read_b128 v[180:183], v11 offset:32768
    ds_read_b128 v[184:187], v10 offset:49152
    ds_read_b128 v[188:191], v11 offset:49152
    ds_read_b128 v[104:107], v12 offset:0
    ds_read_b128 v[108:111], v13 offset:0
    ds_read_b32 v112, v14 offset:0
    ds_read_b128 v[114:117], v12 offset:16384
    ds_read_b128 v[118:121], v13 offset:16384
    ds_read_b32 v122, v14 offset:16384
    s_waitcnt lgkmcnt(15)
    v_pk_add_f32 v[128:129], v[128:129], v[136:137]
    v_pk_add_f32 v[130:131], v[130:131], v[138:139]
    v_pk_add_f32 v[132:133], v[132:133], v[140:141]
    v_pk_add_f32 v[134:135], v[134:135], v[142:143]
    v_pk_add_f32 v[128:129], v[128:129], v[144:145]
    v_pk_add_f32 v[130:131], v[130:131], v[146:147]
    v_pk_add_f32 v[132:133], v[132:133], v[148:149]
    v_pk_add_f32 v[134:135], v[134:135], v[150:151]
    s_waitcnt lgkmcnt(14)
    v_pk_add_f32 v[128:129], v[128:129], v[152:153]
    v_pk_add_f32 v[130:131], v[130:131], v[154:155]
    v_pk_add_f32 v[132:133], v[132:133], v[156:157]
    v_pk_add_f32 v[134:135], v[134:135], v[158:159]
    s_waitcnt lgkmcnt(12)
    v_pk_add_f32 v[128:129], v[128:129], v[160:161]
    v_pk_add_f32 v[130:131], v[130:131], v[162:163]
    v_pk_add_f32 v[132:133], v[132:133], v[164:165]
    v_pk_add_f32 v[134:135], v[134:135], v[166:167]
    s_waitcnt lgkmcnt(10)
    v_pk_add_f32 v[128:129], v[128:129], v[168:169]
    v_pk_add_f32 v[130:131], v[130:131], v[170:171]
    v_pk_add_f32 v[132:133], v[132:133], v[172:173]
    v_pk_add_f32 v[134:135], v[134:135], v[174:175]
    s_waitcnt lgkmcnt(8)
    v_pk_add_f32 v[128:129], v[128:129], v[176:177]
    v_pk_add_f32 v[130:131], v[130:131], v[178:179]
    v_pk_add_f32 v[132:133], v[132:133], v[180:181]
    v_pk_add_f32 v[134:135], v[134:135], v[182:183]
    s_waitcnt lgkmcnt(6)
    v_pk_add_f32 v[128:129], v[128:129], v[184:185]
    v_pk_add_f32 v[130:131], v[130:131], v[186:187]
    v_pk_add_f32 v[132:133], v[132:133], v[188:189]
    v_pk_add_f32 v[134:135], v[134:135], v[190:191]
    v_pk_mul_f32 v[200:201], v[128:129], s[14:15]
    v_pk_mul_f32 v[202:203], v[130:131], s[14:15]
    v_pk_mul_f32 v[204:205], v[132:133], s[14:15]
    v_pk_mul_f32 v[206:207], v[134:135], s[14:15]
    v_exp_f32 v200, v200
    v_exp_f32 v201, v201
    v_exp_f32 v202, v202
    v_exp_f32 v203, v203
    v_exp_f32 v204, v204
    v_exp_f32 v205, v205
    v_exp_f32 v206, v206
    v_exp_f32 v207, v207
    s_waitcnt lgkmcnt(0)
    s_cmp_lg_u32 s69, 0
    s_cbranch_scc1 L_mir1
    v_add_f32 v192, v104, v114
    v_add_f32 v193, v105, v115
    v_add_f32 v194, v106, v116
    v_add_f32 v195, v107, v117
    v_add_f32 v196, v108, v118
    v_add_f32 v197, v109, v119
    v_add_f32 v198, v110, v120
    v_add_f32 v199, v111, v121
    s_branch L_mirj1
L_mir1:
    v_add_f32 v192, v112, v122
    v_add_f32 v193, v111, v121
    v_add_f32 v194, v110, v120
    v_add_f32 v195, v109, v119
    v_add_f32 v196, v108, v118
    v_add_f32 v197, v107, v117
    v_add_f32 v198, v106, v116
    v_add_f32 v199, v105, v115
L_mirj1:
    v_pk_add_f32 v[200:201], v[200:201], s[6:7]
    v_pk_add_f32 v[202:203], v[202:203], s[6:7]
    v_pk_add_f32 v[204:205], v[204:205], s[6:7]
    v_pk_add_f32 v[206:207], v[206:207], s[6:7]
    v_rcp_f32 v200, v200
    v_rcp_f32 v201, v201
    v_rcp_f32 v202, v202
    v_rcp_f32 v203, v203
    v_rcp_f32 v204, v204
    v_rcp_f32 v205, v205
    v_rcp_f32 v206, v206
    v_rcp_f32 v207, v207
    v_pk_mul_f32 v[192:193], v[192:193], v[128:129]
    v_pk_mul_f32 v[194:195], v[194:195], v[130:131]
    v_pk_mul_f32 v[196:197], v[196:197], v[132:133]
    v_pk_mul_f32 v[198:199], v[198:199], v[134:135]
    v_pk_fma_f32 v[96:97], v[192:193], v[200:201], v[96:97]
    v_pk_fma_f32 v[98:99], v[194:195], v[202:203], v[98:99]
    v_pk_fma_f32 v[100:101], v[196:197], v[204:205], v[100:101]
    v_pk_fma_f32 v[102:103], v[198:199], v[206:207], v[102:103]
    v_cvt_pk_bf16_f32 v200, v96, v97
    v_cvt_pk_bf16_f32 v201, v98, v99
    v_cvt_pk_bf16_f32 v202, v100, v101
    v_cvt_pk_bf16_f32 v203, v102, v103
    buffer_store_dwordx4 v[200:203], v18, s[60:63], s74 offen nt
    s_endpgm
.p2align 3
L_dft:
    s_bitcmp1_b32 s3, 0
    s_cselect_b32 s44, s24, s22
    s_cselect_b32 s45, s25, s23
    s_and_b32 s45, s45, 0xffff
    s_mov_b32 s46, 401408
    s_mov_b32 s47, 0x20000
    s_bfe_u32 s5, s2, 0x10002
    v_mul_u32_u24 v3, 896, v22
    s_and_b32 s13, s3, 1
    s_lshl_b32 s13, s13, 6
    v_xor_b32 v14, s13, v14
    s_lshr_b32 s7, s3, 1
    s_lshl2_add_u32 s9, s5, s7
    v_add_u32 v3, v3, v14
    s_mul_i32 s9, s9, 224
    s_add_u32 s9, s9, s79
    s_lshl_b32 s9, s9, 7
    s_mul_i32 s11, s6, 8
    s_add_u32 s11, s11, s3
    s_lshl_b32 s11, s11, 12
    s_add_u32 s5, s5, 14
    s_add_u32 m0, s11, 0
    s_nop 0
    buffer_load_dwordx4 v3, s[44:47], s9 offen lds
    v_xor_b32 v4, 64, v3
    v_add_u32 v4, 7168, v4
    s_add_u32 s10, s9, 14336
    s_add_u32 m0, s11, 1024
    s_nop 0
    buffer_load_dwordx4 v4, s[44:47], s9 offen lds
    s_add_u32 m0, s11, 2048
    s_nop 0
    buffer_load_dwordx4 v3, s[44:47], s10 offen lds
    s_add_u32 m0, s11, 3072
    s_nop 0
    buffer_load_dwordx4 v4, s[44:47], s10 offen lds
    s_add_u32 s79, s79, 1
    s_cmp_eq_u32 s79, 7
    s_cselect_b32 s15, -6, 1
    s_mul_i32 s14, s15, 128
    s_add_u32 s8, s8, s14
    s_add_u32 s0, s0, s14
    s_mul_i32 s14, s15, 128
    s_add_u32 s9, s9, s14
    s_add_u32 s10, s10, s14
    s_lshl_b32 s12, s3, 11
    v_and_b32 v15, 19, v0
    v_bfe_u32 v22, v0, 2, 1
    v_lshl_or_b32 v15, v22, 3, v15
    v_bfe_u32 v22, v0, 3, 1
    v_lshl_or_b32 v15, v22, 2, v15
    v_lshrrev_b32 v22, 5, v0
    v_bfe_u32 v23, v15, 1, 3
    v_xor_b32 v23, v23, v22
    v_lshlrev_b32 v23, 4, v23
    v_lshl_or_b32 v23, v15, 7, v23
    s_and_b32 s6, s3, 1
    s_lshl_b32 s7, s6, 13
    s_add_u32 s7, s7, 98304
    v_add_u32 v6, s7, v23
    v_xor_b32 v7, 32, v6
    v_xor_b32 v8, 64, v6
    v_xor_b32 v9, 96, v6
    s_lshr_b32 s7, s3, 2
    s_mul_i32 s7, s7, 49152
    s_and_b32 s13, s3, 3
    s_lshl_b32 s13, s13, 12
    s_add_u32 s7, s7, s13
    v_add_u32 v10, s7, v23
    v_xor_b32 v11, 32, v10
    v_xor_b32 v12, 64, v10
    v_xor_b32 v13, 96, v10
    v_xor_b32 v36, 4096, v10
    v_xor_b32 v37, 4096, v11
    v_xor_b32 v38, 4096, v12
    v_xor_b32 v39, 4096, v13
    v_mov_b32 v18, 0
    s_barrier
    s_mov_b32 s64, s36
    s_and_b32 s65, s37, 0xffff
    s_mov_b32 s66, 256
    s_mov_b32 s67, 0x20000
    s_or_b32 s74, s74, 1
    s_lshr_b32 s6, s2, 3
    s_or_b32 s6, s6, s3
    s_lshl_b32 s6, s6, 12
    v_mov_b32 v60, s74
    v_mov_b32 v61, 0
    v_lshlrev_b32 v62, 24, v0
    buffer_atomic_cmpswap v[60:61], v62, s[64:67], s6 offen sc1
    s_mov_b32 s74, 0x3f803f80
    s_add_u32 m0, s1, 114688
    s_nop 0
    buffer_load_dwordx4 v2, s[40:43], s8 offen lds
    s_add_u32 m0, s1, 122880
    s_nop 0
    buffer_load_dwordx4 v2, s[40:43], s0 offen lds
    v_lshlrev_b32 v1, 4, v0
    s_waitcnt vmcnt(3)
    s_barrier
    ds_read_b128 v[144:147], v10 offset:0
    ds_read_b128 v[128:131], v6 offset:0
    ds_read_b128 v[148:151], v36 offset:0
    ds_read_b128 v[132:135], v6 offset:4096
    s_waitcnt lgkmcnt(0)
    v_mfma_f32_32x32x16_bf16 v[64:79], v[128:131], v[144:147], 0
    ds_read_b128 v[152:155], v11 offset:0
    ds_read_b128 v[136:139], v7 offset:0
    s_add_u32 m0, s11, 16384
    s_nop 0
    buffer_load_dwordx4 v3, s[44:47], s9 offen lds
    v_mfma_f32_32x32x16_bf16 v[96:111], v[128:131], v[148:151], 0
    ds_read_b128 v[156:159], v37 offset:0
    ds_read_b128 v[140:143], v7 offset:4096
    s_add_u32 m0, s11, 17408
    s_nop 0
    buffer_load_dwordx4 v4, s[44:47], s9 offen lds
    v_mfma_f32_32x32x16_bf16 v[112:127], v[132:135], v[148:151], 0
    s_add_u32 m0, s11, 18432
    s_nop 0
    buffer_load_dwordx4 v3, s[44:47], s10 offen lds
    v_mfma_f32_32x32x16_bf16 v[80:95], v[132:135], v[144:147], 0
    v_dot2c_f32_bf16 v18, s74, v144
    v_dot2c_f32_bf16 v18, s74, v145
    v_dot2c_f32_bf16 v18, s74, v146
    v_dot2c_f32_bf16 v18, s74, v147
    s_add_u32 m0, s11, 19456
    s_nop 0
    buffer_load_dwordx4 v4, s[44:47], s10 offen lds
    s_add_u32 s79, s79, 1
    s_cmp_eq_u32 s79, 7
    s_cselect_b32 s15, -6, 1
    s_mul_i32 s14, s15, 128
    s_add_u32 s8, s8, s14
    s_add_u32 s0, s0, s14
    s_mul_i32 s14, s15, 128
    s_add_u32 s9, s9, s14
    s_add_u32 s10, s10, s14
    s_waitcnt lgkmcnt(0)
    v_mfma_f32_32x32x16_bf16 v[64:79], v[136:139], v[152:155], v[64:79]
    ds_read_b128 v[144:147], v12 offset:0
    ds_read_b128 v[128:131], v8 offset:0
    v_lshlrev_b32 v1, 4, v0
    s_lshl3_add_u32 s76, s5, s3
    s_and_b32 s13, s76, 31
    s_lshl_b32 s13, s13, 6
    s_lshr_b32 s14, s76, 5
    s_bitcmp1_b32 s14, 1
    s_cselect_b32 s6, s77, s4
    s_and_b32 s7, s14, 1
    s_lshl_b32 s7, s7, 5
    s_xor_b32 s6, s6, s7
    s_add_u32 s13, s13, s6
    s_mul_i32 s13, s13, 896
    v_mov_b32 v25, 2130706432
    v_cmp_gt_u32 vcc, 56, v0
    s_nop 1
    v_cndmask_b32 v25, v25, v1, vcc
    buffer_load_dwordx4 v[32:35], v25, s[40:43], s13 offen
    v_mfma_f32_32x32x16_bf16 v[96:111], v[136:139], v[156:159], v[96:111]
    ds_read_b128 v[148:151], v38 offset:0
    ds_read_b128 v[132:135], v8 offset:4096
    s_bitcmp1_b32 s3, 0
    s_cselect_b32 s48, s20, s18
    s_cselect_b32 s49, s21, s19
    s_and_b32 s49, s49, 0xffff
    s_mov_b32 s50, 8388608
    s_mov_b32 s51, 0x20000
    v_lshrrev_b32 v20, 2, v0
    v_and_b32 v21, 3, v0
    v_lshlrev_b32 v21, 4, v21
    v_lshl_add_u32 v20, v20, 18, v21
    s_lshr_b32 s7, s3, 1
    s_bitcmp1_b32 s7, 1
    s_cselect_b32 s6, s77, s4
    s_and_b32 s13, s7, 1
    s_lshl_b32 s13, s13, 5
    s_xor_b32 s6, s6, s13
    s_lshl_b32 s6, s6, 12
    s_add_u32 m0, s12, 147456
    s_nop 0
    buffer_load_dwordx4 v20, s[48:51], s6 offen lds
    s_add_u32 s6, s6, 4194304
    s_add_u32 m0, s12, 148480
    s_nop 0
    buffer_load_dwordx4 v20, s[48:51], s6 offen lds
    v_mfma_f32_32x32x16_bf16 v[112:127], v[140:143], v[156:159], v[112:127]
    s_lshr_b32 s6, s2, 3
    s_lshl3_add_u32 s6, s6, s3
    s_lshl_b32 s6, s6, 7
    s_min_u32 s6, s6, L_end-L_pc
    v_mov_b32 v20, s6
    global_load_dword v186, v20, s[68:69]
    v_mfma_f32_32x32x16_bf16 v[80:95], v[140:143], v[152:155], v[80:95]
    v_dot2c_f32_bf16 v18, s74, v152
    v_dot2c_f32_bf16 v18, s74, v153
    v_dot2c_f32_bf16 v18, s74, v154
    v_dot2c_f32_bf16 v18, s74, v155
    s_add_u32 m0, s1, 131072
    s_nop 0
    buffer_load_dwordx4 v2, s[40:43], s8 offen lds
    s_waitcnt lgkmcnt(0)
    v_mfma_f32_32x32x16_bf16 v[64:79], v[128:131], v[144:147], v[64:79]
    ds_read_b128 v[152:155], v13 offset:0
    ds_read_b128 v[136:139], v9 offset:0
    s_mov_b32 s56, s38
    s_and_b32 s57, s39, 0xffff
    s_mov_b32 s58, 10059776
    s_mov_b32 s59, 0x20000
    v_mfma_f32_32x32x16_bf16 v[96:111], v[128:131], v[148:151], v[96:111]
    ds_read_b128 v[156:159], v39 offset:0
    ds_read_b128 v[140:143], v9 offset:4096
    s_add_u32 m0, s1, 139264
    s_nop 0
    buffer_load_dwordx4 v2, s[40:43], s0 offen lds
    s_lshl_b32 s6, s4, 7
    s_add_u32 s76, s76, s6
    s_lshl_b32 s76, s76, 3
    s_add_u32 s76, s76, 9437184
    v_mfma_f32_32x32x16_bf16 v[112:127], v[132:135], v[148:151], v[112:127]
    s_lshl_b32 s72, s5, 4
    s_add_u32 s72, s72, s4
    s_lshl_b32 s73, s72, 3
    s_add_u32 s73, s73, s3
    v_mfma_f32_32x32x16_bf16 v[80:95], v[132:135], v[144:147], v[80:95]
    v_dot2c_f32_bf16 v18, s74, v144
    v_dot2c_f32_bf16 v18, s74, v145
    v_dot2c_f32_bf16 v18, s74, v146
    v_dot2c_f32_bf16 v18, s74, v147
    s_add_u32 m0, s11, 32768
    s_nop 0
    buffer_load_dwordx4 v3, s[44:47], s9 offen lds
    s_lshl_b32 s73, s73, 8
    s_add_u32 s73, s73, 9502720
    s_and_b32 s6, s72, 0xf8
    s_lshl_b32 s7, s6, 11
    s_waitcnt lgkmcnt(0)
    v_mfma_f32_32x32x16_bf16 v[64:79], v[136:139], v[152:155], v[64:79]
    s_add_u32 s7, s7, 9502720
    s_add_u32 s77, s7, s12
    s_lshl_b32 s13, s4, 10
    s_add_u32 s13, s13, 9437184
    s_waitcnt vmcnt(7)
    s_barrier
    v_mfma_f32_32x32x16_bf16 v[96:111], v[136:139], v[156:159], v[96:111]
    ds_read_b128 v[144:147], v10 offset:16384
    ds_read_b128 v[128:131], v6 offset:16384
    s_cmp_eq_u32 s3, 7
    s_cselect_b32 s77, s13, s77
    v_lshrrev_b32 v20, 5, v0
    v_xor_b32 v20, s3, v20
    v_and_b32 v21, 31, v0
    v_mfma_f32_32x32x16_bf16 v[112:127], v[140:143], v[156:159], v[112:127]
    ds_read_b128 v[148:151], v36 offset:16384
    ds_read_b128 v[132:135], v6 offset:20480
    s_add_u32 m0, s11, 33792
    s_nop 0
    buffer_load_dwordx4 v4, s[44:47], s9 offen lds
    v_lshlrev_b32 v21, 3, v21
    v_lshl_add_u32 v20, v20, 8, v21
    v_add_u32 v43, s7, v20
    v_add_u32 v52, 147456, v20
    v_mfma_f32_32x32x16_bf16 v[80:95], v[140:143], v[152:155], v[80:95]
    v_dot2c_f32_bf16 v18, s74, v152
    v_dot2c_f32_bf16 v18, s74, v153
    v_dot2c_f32_bf16 v18, s74, v154
    v_dot2c_f32_bf16 v18, s74, v155
    s_add_u32 m0, s11, 34816
    s_nop 0
    buffer_load_dwordx4 v3, s[44:47], s10 offen lds
    s_and_b32 s6, s3, 1
    s_lshl_b32 s6, s6, 9
    v_lshl_add_u32 v20, v15, 3, s6
    v_add_u32 v42, s13, v20
    s_waitcnt lgkmcnt(0)
    v_mfma_f32_32x32x16_bf16 v[64:79], v[128:131], v[144:147], v[64:79]
    ds_read_b128 v[152:155], v11 offset:16384
    ds_read_b128 v[136:139], v7 offset:16384
    v_add_u32 v60, 161792, v20
    s_lshl_b32 s72, s4, 4
    s_add_u32 s72, s72, s5
    s_lshl_b32 s72, s72, 7
    v_mfma_f32_32x32x16_bf16 v[96:111], v[128:131], v[148:151], v[96:111]
    ds_read_b128 v[156:159], v37 offset:16384
    ds_read_b128 v[140:143], v7 offset:20480
    s_add_u32 m0, s11, 35840
    s_nop 0
    buffer_load_dwordx4 v4, s[44:47], s10 offen lds
    s_add_u32 s79, s79, 1
    s_cmp_eq_u32 s79, 7
    s_cselect_b32 s15, -6, 1
    s_mul_i32 s14, s15, 128
    s_add_u32 s8, s8, s14
    s_add_u32 s0, s0, s14
    s_mul_i32 s14, s15, 128
    s_add_u32 s9, s9, s14
    s_add_u32 s10, s10, s14
    s_lshl_b32 s6, s3, 2
    s_add_u32 s72, s72, s6
    s_add_u32 s72, s72, 10027008
    buffer_load_dword v57, v61, s[64:67], 0 offen sc1
    v_mfma_f32_32x32x16_bf16 v[112:127], v[132:135], v[148:151], v[112:127]
    s_waitcnt vmcnt(10)
    v_mov_b32 v28, 0
    v_mov_b32 v29, 0
    v_dot2c_f32_bf16 v28, s74, v32
    v_dot2c_f32_bf16 v29, v32, v32
    v_dot2c_f32_bf16 v28, s74, v33
    v_dot2c_f32_bf16 v29, v33, v33
    v_dot2c_f32_bf16 v28, s74, v34
    v_dot2c_f32_bf16 v29, v34, v34
    v_dot2c_f32_bf16 v28, s74, v35
    v_dot2c_f32_bf16 v29, v35, v35
    s_nop 2
    v_permlane32_swap_b32 v28, v29
    v_add_f32 v28, v28, v29
    v_mov_b32 v30, v28
    v_mfma_f32_32x32x16_bf16 v[80:95], v[132:135], v[144:147], v[80:95]
    s_add_u32 m0, s1, 98304
    s_nop 0
    buffer_load_dwordx4 v2, s[40:43], s8 offen lds
    v_permlane16_swap_b32 v28, v30
    v_add_f32 v28, v28, v30
    s_nop 1
    v_add_f32_dpp v28, v28, v28 row_ror:8 row_mask:0xf bank_mask:0xf
    s_nop 1
    v_add_f32_dpp v28, v28, v28 row_ror:4 row_mask:0xf bank_mask:0xf
    s_waitcnt lgkmcnt(0)
    v_mfma_f32_32x32x16_bf16 v[64:79], v[136:139], v[152:155], v[64:79]
    ds_read_b128 v[144:147], v12 offset:16384
    ds_read_b128 v[128:131], v8 offset:16384
    v_add_f32_dpp v28, v28, v28 row_ror:2 row_mask:0xf bank_mask:0xf
    s_nop 1
    v_add_f32_dpp v28, v28, v28 row_ror:1 row_mask:0xf bank_mask:0xf
    v_mul_f32 v28, 0x3b124925, v28
    v_mov_b32 v29, v28
    v_mfma_f32_32x32x16_bf16 v[96:111], v[136:139], v[156:159], v[96:111]
    ds_read_b128 v[148:151], v38 offset:16384
    ds_read_b128 v[132:135], v8 offset:20480
    s_add_u32 m0, s1, 106496
    s_nop 0
    buffer_load_dwordx4 v2, s[40:43], s0 offen lds
    v_permlane32_swap_b32 v28, v29
    v_fma_f32 v29, -v28, v28, v29
    v_max_f32 v29, 0, v29
    v_cvt_pk_bf16_f32 v29, v29, v29
    v_mfma_f32_32x32x16_bf16 v[112:127], v[140:143], v[156:159], v[112:127]
    v_lshlrev_b32 v29, 16, v29
    v_add_f32 v29, 0x3727c5ac, v29
    v_cvt_pk_bf16_f32 v29, v29, v29
    v_lshlrev_b32 v29, 16, v29
    v_mfma_f32_32x32x16_bf16 v[80:95], v[140:143], v[152:155], v[80:95]
    s_add_u32 m0, s11, 0
    s_nop 0
    buffer_load_dwordx4 v3, s[44:47], s9 offen lds
    v_sqrt_f32 v29, v29
    s_nop 0
    v_cvt_pk_bf16_f32 v56, v28, v29
    s_waitcnt vmcnt(3)
    v_cmp_eq_u32 vcc, 0, v57
    s_nop 1
    s_cbranch_vccz L_ok5
    s_mov_b32 s75, 0x10000
L_spin5:
    s_sleep 2
    buffer_load_dword v57, v61, s[64:67], 0 offen sc1
    s_waitcnt vmcnt(0)
    v_cmp_eq_u32 vcc, 0, v57
    s_nop 1
    s_cbranch_vccz L_ok5
    s_sub_u32 s75, s75, 1
    s_cmp_lg_u32 s75, 0
    s_cbranch_scc1 L_spin5
L_ok5:
    v_readfirstlane_b32 s78, v57
    s_waitcnt lgkmcnt(0)
    v_mfma_f32_32x32x16_bf16 v[64:79], v[128:131], v[144:147], v[64:79]
    ds_read_b128 v[152:155], v13 offset:16384
    ds_read_b128 v[136:139], v9 offset:16384
    buffer_store_dwordx2 v[56:57], v62, s[56:59], s76 offen sc1
    v_mov_b32 v58, v18
    v_mov_b32 v59, v57
    v_and_b32 v28, 31, v0
    v_mfma_f32_32x32x16_bf16 v[96:111], v[128:131], v[148:151], v[96:111]
    ds_read_b128 v[156:159], v39 offset:16384
    ds_read_b128 v[140:143], v9 offset:20480
    s_add_u32 m0, s11, 1024
    s_nop 0
    buffer_load_dwordx4 v4, s[44:47], s9 offen lds
    v_permlane32_swap_b32 v18, v58
    v_lshlrev_b32 v28, 3, v28
    v_add_f32 v58, v18, v58
    buffer_store_dwordx2 v[58:59], v28, s[56:59], s73 offen sc1
    v_mfma_f32_32x32x16_bf16 v[112:127], v[132:135], v[148:151], v[112:127]
    v_lshrrev_b32 v20, 5, v0
    v_lshlrev_b32 v40, 9, v20
    v_bfe_u32 v20, v0, 2, 2
    v_lshl_or_b32 v40, v20, 6, v40
    v_mfma_f32_32x32x16_bf16 v[80:95], v[132:135], v[144:147], v[80:95]
    s_add_u32 m0, s11, 2048
    s_nop 0
    buffer_load_dwordx4 v3, s[44:47], s10 offen lds
    v_bfe_u32 v20, v0, 4, 1
    v_lshl_or_b32 v40, v20, 5, v40
    v_and_b32 v20, 3, v0
    v_lshl_or_b32 v40, v20, 3, v40
    s_waitcnt lgkmcnt(0)
    v_mfma_f32_32x32x16_bf16 v[64:79], v[136:139], v[152:155], v[64:79]
    s_and_b32 s6, s3, 1
    s_mul_i32 s6, s6, 10240
    s_add_u32 s6, s6, 147456
    v_add_u32 v40, s6, v40
    s_barrier
    v_mfma_f32_32x32x16_bf16 v[96:111], v[136:139], v[156:159], v[96:111]
    ds_read_b128 v[144:147], v10 offset:32768
    ds_read_b128 v[128:131], v6 offset:32768
    v_xor_b32 v41, 2048, v40
    v_mfma_f32_32x32x16_bf16 v[112:127], v[140:143], v[156:159], v[112:127]
    ds_read_b128 v[148:151], v36 offset:32768
    ds_read_b128 v[132:135], v6 offset:36864
    ds_read_b64_tr_b16 v[192:193], v40 offset:0
    ds_read_b64_tr_b16 v[194:195], v40 offset:256
    ds_read_b64_tr_b16 v[208:209], v41 offset:0
    ds_read_b64_tr_b16 v[210:211], v41 offset:256
    v_mfma_f32_32x32x16_bf16 v[80:95], v[140:143], v[152:155], v[80:95]
    s_add_u32 m0, s11, 3072
    s_nop 0
    buffer_load_dwordx4 v4, s[44:47], s10 offen lds
    s_add_u32 s79, s79, 1
    s_cmp_eq_u32 s79, 7
    s_cselect_b32 s15, -6, 1
    s_mul_i32 s14, s15, 128
    s_add_u32 s8, s8, s14
    s_add_u32 s0, s0, s14
    s_mul_i32 s14, s15, 128
    s_add_u32 s9, s9, s14
    s_add_u32 s10, s10, s14
    ds_read_b64_tr_b16 v[196:197], v40 offset:1024
    ds_read_b64_tr_b16 v[198:199], v40 offset:1280
    ds_read_b64_tr_b16 v[212:213], v41 offset:1024
    ds_read_b64_tr_b16 v[214:215], v41 offset:1280
    s_waitcnt lgkmcnt(0)
    v_mfma_f32_32x32x16_bf16 v[64:79], v[128:131], v[144:147], v[64:79]
    ds_read_b128 v[152:155], v11 offset:32768
    ds_read_b128 v[136:139], v7 offset:32768
    ds_read_b64_tr_b16 v[200:201], v40 offset:4096
    ds_read_b64_tr_b16 v[202:203], v40 offset:4352
    ds_read_b64_tr_b16 v[216:217], v41 offset:4096
    ds_read_b64_tr_b16 v[218:219], v41 offset:4352
    v_mfma_f32_32x32x16_bf16 v[96:111], v[128:131], v[148:151], v[96:111]
    ds_read_b128 v[156:159], v37 offset:32768
    ds_read_b128 v[140:143], v7 offset:36864
    s_add_u32 m0, s1, 114688
    s_nop 0
    buffer_load_dwordx4 v2, s[40:43], s8 offen lds
    ds_read_b64_tr_b16 v[204:205], v40 offset:5120
    ds_read_b64_tr_b16 v[206:207], v40 offset:5376
    ds_read_b64_tr_b16 v[220:221], v41 offset:5120
    ds_read_b64_tr_b16 v[222:223], v41 offset:5376
    v_mfma_f32_32x32x16_bf16 v[112:127], v[132:135], v[148:151], v[112:127]
    s_bitcmp1_b32 s3, 0
    s_cselect_b32 s26, 0x80008000, 0
    s_xor_b32 s27, s26, 0x80008000
    v_and_b32 v20, 31, v0
    v_mfma_f32_32x32x16_bf16 v[80:95], v[132:135], v[144:147], v[80:95]
    s_add_u32 m0, s1, 122880
    s_nop 0
    buffer_load_dwordx4 v2, s[40:43], s0 offen lds
    v_lshrrev_b32 v21, 5, v0
    v_and_b32 v22, 7, v0
    v_xor_b32 v21, v21, v22
    v_lshlrev_b32 v21, 4, v21
    s_waitcnt lgkmcnt(0)
    v_mfma_f32_32x32x16_bf16 v[64:79], v[136:139], v[152:155], v[64:79]
    ds_read_b128 v[144:147], v12 offset:32768
    ds_read_b128 v[128:131], v8 offset:32768
    v_lshl_or_b32 v48, v20, 7, v21
    s_lshl_b32 s6, s3, 13
    v_add_u32 v48, s6, v48
    v_xor_b32 v49, 32, v48
    v_mfma_f32_32x32x16_bf16 v[96:111], v[136:139], v[156:159], v[96:111]
    ds_read_b128 v[148:151], v38 offset:32768
    ds_read_b128 v[132:135], v8 offset:36864
    s_add_u32 m0, s11, 16384
    s_nop 0
    buffer_load_dwordx4 v3, s[44:47], s9 offen lds
    v_xor_b32 v50, 64, v48
    v_xor_b32 v51, 96, v48
    v_lshrrev_b32 v20, 3, v0
    v_lshlrev_b32 v21, 4, v20
    v_mfma_f32_32x32x16_bf16 v[112:127], v[140:143], v[156:159], v[112:127]
    v_xor_b32 v16, v21, v1
    v_add_u32 v16, s6, v16
    v_lshlrev_b32 v22, 4, v22
    v_lshl_add_u32 v53, v20, 16, v22
    v_mfma_f32_32x32x16_bf16 v[80:95], v[140:143], v[152:155], v[80:95]
    s_add_u32 m0, s11, 17408
    s_nop 0
    buffer_load_dwordx4 v4, s[44:47], s9 offen lds
    s_sub_u32 s6, s5, 14
    s_lshr_b32 s7, s3, 1
    s_lshl2_add_u32 s70, s6, s7
    s_lshl_b32 s70, s70, 12
    s_waitcnt lgkmcnt(0)
    v_mfma_f32_32x32x16_bf16 v[64:79], v[128:131], v[144:147], v[64:79]
    ds_read_b128 v[152:155], v13 offset:32768
    ds_read_b128 v[136:139], v9 offset:32768
    s_and_b32 s6, s3, 1
    s_lshl1_add_u32 s6, s4, s6
    s_lshl_b32 s6, s6, 7
    s_add_u32 s70, s70, s6
    v_mfma_f32_32x32x16_bf16 v[96:111], v[128:131], v[148:151], v[96:111]
    ds_read_b128 v[156:159], v39 offset:32768
    ds_read_b128 v[140:143], v9 offset:36864
    s_add_u32 m0, s11, 18432
    s_nop 0
    buffer_load_dwordx4 v3, s[44:47], s10 offen lds
    s_add_u32 s70, s70, 7340032
    s_lshl_b32 s71, s3, 9
    s_add_u32 s71, s71, 114688
    v_lshrrev_b32 v19, 5, v0
    v_mfma_f32_32x32x16_bf16 v[112:127], v[132:135], v[148:151], v[112:127]
    v_lshl_add_u32 v19, v19, 5, s71
    v_mfma_f32_32x32x16_bf16 v[80:95], v[132:135], v[144:147], v[80:95]
    s_add_u32 m0, s11, 19456
    s_nop 0
    buffer_load_dwordx4 v4, s[44:47], s10 offen lds
    s_add_u32 s79, s79, 1
    s_cmp_eq_u32 s79, 7
    s_cselect_b32 s15, -6, 1
    s_mul_i32 s14, s15, 128
    s_add_u32 s8, s8, s14
    s_add_u32 s0, s0, s14
    s_mul_i32 s14, s15, 128
    s_add_u32 s9, s9, s14
    s_add_u32 s10, s10, s14
    s_waitcnt lgkmcnt(0)
    v_mfma_f32_32x32x16_bf16 v[64:79], v[136:139], v[152:155], v[64:79]
    s_waitcnt vmcnt(6)
    s_barrier
    v_mfma_f32_32x32x16_bf16 v[96:111], v[136:139], v[156:159], v[96:111]
    ds_read_b128 v[144:147], v10 offset:0
    ds_read_b128 v[128:131], v6 offset:0
    v_mfma_f32_32x32x16_bf16 v[112:127], v[140:143], v[156:159], v[112:127]
    ds_read_b128 v[148:151], v36 offset:0
    ds_read_b128 v[132:135], v6 offset:4096
    v_mfma_f32_32x32x16_bf16 v[80:95], v[140:143], v[152:155], v[80:95]
    s_add_u32 m0, s1, 131072
    s_nop 0
    buffer_load_dwordx4 v2, s[40:43], s8 offen lds
    s_waitcnt lgkmcnt(0)
    v_mfma_f32_32x32x16_bf16 v[64:79], v[128:131], v[144:147], v[64:79]
    ds_read_b128 v[152:155], v11 offset:0
    ds_read_b128 v[136:139], v7 offset:0
    v_xor_b32 v224, s26, v192
    v_xor_b32 v240, s27, v208
    v_xor_b32 v225, s26, v193
    v_xor_b32 v241, s27, v209
    v_mfma_f32_32x32x16_bf16 v[96:111], v[128:131], v[148:151], v[96:111]
    ds_read_b128 v[156:159], v37 offset:0
    ds_read_b128 v[140:143], v7 offset:4096
    s_add_u32 m0, s1, 139264
    s_nop 0
    buffer_load_dwordx4 v2, s[40:43], s0 offen lds
    v_xor_b32 v226, s26, v194
    v_xor_b32 v242, s27, v210
    v_xor_b32 v227, s26, v195
    v_xor_b32 v243, s27, v211
    v_mfma_f32_32x32x16_bf16 v[112:127], v[132:135], v[148:151], v[112:127]
    v_xor_b32 v228, s26, v196
    v_xor_b32 v244, s27, v212
    v_xor_b32 v229, s26, v197
    v_xor_b32 v245, s27, v213
    v_mfma_f32_32x32x16_bf16 v[80:95], v[132:135], v[144:147], v[80:95]
    s_add_u32 m0, s11, 32768
    s_nop 0
    buffer_load_dwordx4 v3, s[44:47], s9 offen lds
    v_xor_b32 v230, s26, v198
    v_xor_b32 v246, s27, v214
    v_xor_b32 v231, s26, v199
    v_xor_b32 v247, s27, v215
    s_waitcnt lgkmcnt(0)
    v_mfma_f32_32x32x16_bf16 v[64:79], v[136:139], v[152:155], v[64:79]
    ds_read_b128 v[144:147], v12 offset:0
    ds_read_b128 v[128:131], v8 offset:0
    v_xor_b32 v232, s26, v200
    v_xor_b32 v248, s27, v216
    v_xor_b32 v233, s26, v201
    v_xor_b32 v249, s27, v217
    v_mfma_f32_32x32x16_bf16 v[96:111], v[136:139], v[156:159], v[96:111]
    ds_read_b128 v[148:151], v38 offset:0
    ds_read_b128 v[132:135], v8 offset:4096
    s_add_u32 m0, s11, 33792
    s_nop 0
    buffer_load_dwordx4 v4, s[44:47], s9 offen lds
    v_xor_b32 v234, s26, v202
    v_xor_b32 v250, s27, v218
    v_xor_b32 v235, s26, v203
    v_xor_b32 v251, s27, v219
    v_mfma_f32_32x32x16_bf16 v[112:127], v[140:143], v[156:159], v[112:127]
    v_xor_b32 v236, s26, v204
    v_xor_b32 v252, s27, v220
    v_xor_b32 v237, s26, v205
    v_xor_b32 v253, s27, v221
    v_mfma_f32_32x32x16_bf16 v[80:95], v[140:143], v[152:155], v[80:95]
    s_add_u32 m0, s11, 34816
    s_nop 0
    buffer_load_dwordx4 v3, s[44:47], s10 offen lds
    v_xor_b32 v238, s26, v206
    v_xor_b32 v254, s27, v222
    v_xor_b32 v239, s26, v207
    v_xor_b32 v255, s27, v223
    s_waitcnt lgkmcnt(0)
    v_mfma_f32_32x32x16_bf16 v[64:79], v[128:131], v[144:147], v[64:79]
    ds_read_b128 v[152:155], v13 offset:0
    ds_read_b128 v[136:139], v9 offset:0
    v_mfma_f32_32x32x16_bf16 v[96:111], v[128:131], v[148:151], v[96:111]
    ds_read_b128 v[156:159], v39 offset:0
    ds_read_b128 v[140:143], v9 offset:4096
    s_add_u32 m0, s11, 35840
    s_nop 0
    buffer_load_dwordx4 v4, s[44:47], s10 offen lds
    s_add_u32 s79, s79, 1
    s_cmp_eq_u32 s79, 7
    s_cselect_b32 s15, -6, 1
    s_mul_i32 s14, s15, 128
    s_add_u32 s8, s8, s14
    s_add_u32 s0, s0, s14
    s_mul_i32 s14, s15, 128
    s_add_u32 s9, s9, s14
    s_add_u32 s10, s10, s14
    v_mfma_f32_32x32x16_bf16 v[112:127], v[132:135], v[148:151], v[112:127]
    v_mfma_f32_32x32x16_bf16 v[80:95], v[132:135], v[144:147], v[80:95]
    s_waitcnt lgkmcnt(0)
    v_mfma_f32_32x32x16_bf16 v[64:79], v[136:139], v[152:155], v[64:79]
    s_waitcnt vmcnt(6)
    s_barrier
    v_mfma_f32_32x32x16_bf16 v[96:111], v[136:139], v[156:159], v[96:111]
    ds_read_b128 v[144:147], v10 offset:16384
    ds_read_b128 v[128:131], v6 offset:16384
    v_mfma_f32_32x32x16_bf16 v[112:127], v[140:143], v[156:159], v[112:127]
    ds_read_b128 v[148:151], v36 offset:16384
    ds_read_b128 v[132:135], v6 offset:20480
    s_add_u32 m0, s1, 98304
    s_nop 0
    buffer_load_dwordx4 v2, s[40:43], s8 offen lds
    v_mfma_f32_32x32x16_bf16 v[80:95], v[140:143], v[152:155], v[80:95]
    s_add_u32 m0, s1, 106496
    s_nop 0
    buffer_load_dwordx4 v2, s[40:43], s0 offen lds
    s_waitcnt lgkmcnt(0)
    v_mfma_f32_32x32x16_bf16 v[64:79], v[128:131], v[144:147], v[64:79]
    ds_read_b128 v[152:155], v11 offset:16384
    ds_read_b128 v[136:139], v7 offset:16384
    v_mfma_f32_32x32x16_bf16 v[96:111], v[128:131], v[148:151], v[96:111]
    ds_read_b128 v[156:159], v37 offset:16384
    ds_read_b128 v[140:143], v7 offset:20480
    s_add_u32 m0, s11, 0
    s_nop 0
    buffer_load_dwordx4 v3, s[44:47], s9 offen lds
    v_mfma_f32_32x32x16_bf16 v[112:127], v[132:135], v[148:151], v[112:127]
    v_mfma_f32_32x32x16_bf16 v[80:95], v[132:135], v[144:147], v[80:95]
    s_add_u32 m0, s11, 1024
    s_nop 0
    buffer_load_dwordx4 v4, s[44:47], s9 offen lds
    s_waitcnt lgkmcnt(0)
    v_mfma_f32_32x32x16_bf16 v[64:79], v[136:139], v[152:155], v[64:79]
    ds_read_b128 v[144:147], v12 offset:16384
    ds_read_b128 v[128:131], v8 offset:16384
    v_mfma_f32_32x32x16_bf16 v[96:111], v[136:139], v[156:159], v[96:111]
    ds_read_b128 v[148:151], v38 offset:16384
    ds_read_b128 v[132:135], v8 offset:20480
    s_add_u32 m0, s11, 2048
    s_nop 0
    buffer_load_dwordx4 v3, s[44:47], s10 offen lds
    v_mfma_f32_32x32x16_bf16 v[112:127], v[140:143], v[156:159], v[112:127]
    v_mfma_f32_32x32x16_bf16 v[80:95], v[140:143], v[152:155], v[80:95]
    s_add_u32 m0, s11, 3072
    s_nop 0
    buffer_load_dwordx4 v4, s[44:47], s10 offen lds
    s_waitcnt lgkmcnt(0)
    v_mfma_f32_32x32x16_bf16 v[64:79], v[128:131], v[144:147], v[64:79]
    ds_read_b128 v[152:155], v13 offset:16384
    ds_read_b128 v[136:139], v9 offset:16384
    v_mfma_f32_32x32x16_bf16 v[96:111], v[128:131], v[148:151], v[96:111]
    ds_read_b128 v[156:159], v39 offset:16384
    ds_read_b128 v[140:143], v9 offset:20480
    s_add_u32 m0, s12, 147456
    s_nop 0
    buffer_load_dwordx4 v1, s[56:59], s77 offen sc1 lds
    v_mfma_f32_32x32x16_bf16 v[112:127], v[132:135], v[148:151], v[112:127]
    v_mfma_f32_32x32x16_bf16 v[80:95], v[132:135], v[144:147], v[80:95]
    s_add_u32 m0, s12, 147456
    s_nop 0
    buffer_load_dwordx4 v1, s[56:59], s77 offen offset:1024 sc1 lds
    s_waitcnt lgkmcnt(0)
    v_mfma_f32_32x32x16_bf16 v[64:79], v[136:139], v[152:155], v[64:79]
    s_waitcnt vmcnt(8)
    s_barrier
    v_mfma_f32_32x32x16_bf16 v[96:111], v[136:139], v[156:159], v[96:111]
    ds_read_b128 v[144:147], v10 offset:32768
    ds_read_b128 v[128:131], v6 offset:32768
    v_mfma_f32_32x32x16_bf16 v[112:127], v[140:143], v[156:159], v[112:127]
    ds_read_b128 v[148:151], v36 offset:32768
    ds_read_b128 v[132:135], v6 offset:36864
    v_mfma_f32_32x32x16_bf16 v[80:95], v[140:143], v[152:155], v[80:95]
    s_waitcnt lgkmcnt(0)
    v_mfma_f32_32x32x16_bf16 v[64:79], v[128:131], v[144:147], v[64:79]
    ds_read_b128 v[152:155], v11 offset:32768
    ds_read_b128 v[136:139], v7 offset:32768
    v_mfma_f32_32x32x16_bf16 v[96:111], v[128:131], v[148:151], v[96:111]
    ds_read_b128 v[156:159], v37 offset:32768
    ds_read_b128 v[140:143], v7 offset:36864
    v_mfma_f32_32x32x16_bf16 v[112:127], v[132:135], v[148:151], v[112:127]
    v_mfma_f32_32x32x16_bf16 v[80:95], v[132:135], v[144:147], v[80:95]
    s_waitcnt lgkmcnt(0)
    v_mfma_f32_32x32x16_bf16 v[64:79], v[136:139], v[152:155], v[64:79]
    ds_read_b128 v[144:147], v12 offset:32768
    ds_read_b128 v[128:131], v8 offset:32768
    v_mfma_f32_32x32x16_bf16 v[96:111], v[136:139], v[156:159], v[96:111]
    ds_read_b128 v[148:151], v38 offset:32768
    ds_read_b128 v[132:135], v8 offset:36864
    v_mfma_f32_32x32x16_bf16 v[112:127], v[140:143], v[156:159], v[112:127]
    v_mfma_f32_32x32x16_bf16 v[80:95], v[140:143], v[152:155], v[80:95]
    s_waitcnt lgkmcnt(0)
    v_mfma_f32_32x32x16_bf16 v[64:79], v[128:131], v[144:147], v[64:79]
    ds_read_b128 v[152:155], v13 offset:32768
    ds_read_b128 v[136:139], v9 offset:32768
    v_mfma_f32_32x32x16_bf16 v[96:111], v[128:131], v[148:151], v[96:111]
    ds_read_b128 v[156:159], v39 offset:32768
    ds_read_b128 v[140:143], v9 offset:36864
    v_mfma_f32_32x32x16_bf16 v[112:127], v[132:135], v[148:151], v[112:127]
    v_mfma_f32_32x32x16_bf16 v[80:95], v[132:135], v[144:147], v[80:95]
    s_waitcnt lgkmcnt(0)
    v_mfma_f32_32x32x16_bf16 v[64:79], v[136:139], v[152:155], v[64:79]
    s_waitcnt vmcnt(0)
    s_barrier
    v_mfma_f32_32x32x16_bf16 v[96:111], v[136:139], v[156:159], v[96:111]
    ds_read_b128 v[144:147], v10 offset:0
    ds_read_b128 v[128:131], v6 offset:0
    v_mfma_f32_32x32x16_bf16 v[112:127], v[140:143], v[156:159], v[112:127]
    ds_read_b128 v[148:151], v36 offset:0
    ds_read_b128 v[132:135], v6 offset:4096
    ds_read_b64 v[44:45], v60
    ds_read_b64 v[46:47], v60 offset:256
    ds_read_b64 v[160:161], v52 offset:0
    ds_read_b64 v[162:163], v52 offset:2048
    v_mfma_f32_32x32x16_bf16 v[80:95], v[140:143], v[152:155], v[80:95]
    ds_read_b64 v[164:165], v52 offset:4096
    ds_read_b64 v[166:167], v52 offset:6144
    ds_read_b64 v[168:169], v52 offset:8192
    ds_read_b64 v[170:171], v52 offset:10240
    s_waitcnt lgkmcnt(0)
    v_mfma_f32_32x32x16_bf16 v[64:79], v[128:131], v[144:147], v[64:79]
    ds_read_b128 v[152:155], v11 offset:0
    ds_read_b128 v[136:139], v7 offset:0
    ds_read_b64 v[172:173], v52 offset:12288
    v_mfma_f32_32x32x16_bf16 v[96:111], v[128:131], v[148:151], v[96:111]
    ds_read_b128 v[156:159], v37 offset:0
    ds_read_b128 v[140:143], v7 offset:4096
    v_mfma_f32_32x32x16_bf16 v[112:127], v[132:135], v[148:151], v[112:127]
    v_mfma_f32_32x32x16_bf16 v[80:95], v[132:135], v[144:147], v[80:95]
    s_waitcnt lgkmcnt(0)
    v_mfma_f32_32x32x16_bf16 v[64:79], v[136:139], v[152:155], v[64:79]
    ds_read_b128 v[144:147], v12 offset:0
    ds_read_b128 v[128:131], v8 offset:0
    v_min3_u32 v20, v45, v47, v161
    v_max3_u32 v21, v45, v47, v161
    v_min3_u32 v20, v20, v163, v165
    v_max3_u32 v21, v21, v163, v165
    v_mfma_f32_32x32x16_bf16 v[96:111], v[136:139], v[156:159], v[96:111]
    ds_read_b128 v[148:151], v38 offset:0
    ds_read_b128 v[132:135], v8 offset:4096
    v_min3_u32 v20, v20, v167, v169
    v_max3_u32 v21, v21, v167, v169
    v_min3_u32 v20, v20, v171, v173
    v_max3_u32 v21, v21, v171, v173
    v_mfma_f32_32x32x16_bf16 v[112:127], v[140:143], v[156:159], v[112:127]
    v_xor_b32 v20, s78, v20
    v_xor_b32 v21, s78, v21
    v_or_b32 v20, v20, v21
    v_cmp_ne_u32 vcc, 0, v20
    s_nop 1
    s_cbranch_vccz L_ok6
    s_mov_b32 s75, 0x10000
L_spin6:
    s_sleep 1
    buffer_load_dwordx2 v[44:45], v42, s[56:59], 0 offen sc1
    buffer_load_dwordx2 v[46:47], v42, s[56:59], 0 offen offset:256 sc1
    s_mov_b32 s6, 0
    buffer_load_dwordx2 v[160:161], v43, s[56:59], s6 offen sc1
    s_add_u32 s6, s6, 2048
    buffer_load_dwordx2 v[162:163], v43, s[56:59], s6 offen sc1
    s_add_u32 s6, s6, 2048
    buffer_load_dwordx2 v[164:165], v43, s[56:59], s6 offen sc1
    s_add_u32 s6, s6, 2048
    buffer_load_dwordx2 v[166:167], v43, s[56:59], s6 offen sc1
    s_add_u32 s6, s6, 2048
    buffer_load_dwordx2 v[168:169], v43, s[56:59], s6 offen sc1
    s_add_u32 s6, s6, 2048
    buffer_load_dwordx2 v[170:171], v43, s[56:59], s6 offen sc1
    s_add_u32 s6, s6, 2048
    buffer_load_dwordx2 v[172:173], v43, s[56:59], s6 offen sc1
    s_add_u32 s6, s6, 2048
    s_waitcnt vmcnt(0)
    v_min3_u32 v20, v45, v47, v161
    v_max3_u32 v21, v45, v47, v161
    v_min3_u32 v20, v20, v163, v165
    v_max3_u32 v21, v21, v163, v165
    v_min3_u32 v20, v20, v167, v169
    v_max3_u32 v21, v21, v167, v169
    v_min3_u32 v20, v20, v171, v173
    v_max3_u32 v21, v21, v171, v173
    v_xor_b32 v20, s78, v20
    v_xor_b32 v21, s78, v21
    v_or_b32 v20, v20, v21
    v_cmp_ne_u32 vcc, 0, v20
    s_nop 1
    s_cbranch_vccz L_ok6
    s_sub_u32 s75, s75, 1
    s_cmp_lg_u32 s75, 0
    s_cbranch_scc1 L_spin6
L_ok6:
    v_mfma_f32_32x32x16_bf16 v[80:95], v[140:143], v[152:155], v[80:95]
    v_add_f32 v160, v160, v162
    v_add_f32 v160, v160, v164
    v_add_f32 v160, v160, v166
    v_add_f32 v160, v160, v168
    s_waitcnt lgkmcnt(0)
    v_mfma_f32_32x32x16_bf16 v[64:79], v[128:131], v[144:147], v[64:79]
    ds_read_b128 v[152:155], v13 offset:0
    ds_read_b128 v[136:139], v9 offset:0
    v_add_f32 v160, v160, v170
    v_add_f32 v160, v160, v172
    v_and_b32 v20, 0xffff0000, v160
    v_sub_f32 v21, v160, v20
    v_mfma_f32_32x32x16_bf16 v[96:111], v[128:131], v[148:151], v[96:111]
    ds_read_b128 v[156:159], v39 offset:0
    ds_read_b128 v[140:143], v9 offset:4096
    v_and_b32 v22, 0xffff0000, v21
    v_sub_f32 v21, v21, v22
    v_lshrrev_b32 v20, 16, v20
    v_or_b32 v54, v20, v22
    v_mfma_f32_32x32x16_bf16 v[112:127], v[132:135], v[148:151], v[112:127]
    v_lshrrev_b32 v55, 16, v21
    v_cmp_gt_u32 vcc, 32, v0
    v_and_b32 v20, 0xffff, v44
    v_xor_b32 v20, 0x8000, v20
    v_mfma_f32_32x32x16_bf16 v[80:95], v[132:135], v[144:147], v[80:95]
    v_lshl_or_b32 v21, v20, 16, v20
    v_cndmask_b32 v176, 0, v21, vcc
    v_cndmask_b32 v177, 0, v20, vcc
    v_cndmask_b32 v180, v21, v61, vcc
    s_waitcnt lgkmcnt(0)
    v_mfma_f32_32x32x16_bf16 v[64:79], v[136:139], v[152:155], v[64:79]
    v_cndmask_b32 v181, v20, v61, vcc
    v_and_b32 v45, 0xffff0000, v44
    v_and_b32 v20, 0xffff, v46
    v_xor_b32 v20, 0x8000, v20
    s_barrier
    v_mfma_f32_32x32x16_bf16 v[96:111], v[136:139], v[156:159], v[96:111]
    v_lshl_or_b32 v21, v20, 16, v20
    v_cndmask_b32 v178, 0, v21, vcc
    v_cndmask_b32 v179, 0, v20, vcc
    v_cndmask_b32 v182, v21, v61, vcc
    v_mfma_f32_32x32x16_bf16 v[112:127], v[140:143], v[156:159], v[112:127]
    v_cndmask_b32 v183, v20, v61, vcc
    v_and_b32 v47, 0xffff0000, v46
    v_mfma_f32_32x32x16_bf16 v[80:95], v[140:143], v[152:155], v[80:95]
    v_mfma_f32_32x32x8_bf16 v[64:79], v[176:177], v[54:55], v[64:79]
    s_nop 0
    v_mfma_f32_32x32x8_bf16 v[96:111], v[180:181], v[54:55], v[96:111]
    s_nop 3
    v_mfma_f32_32x32x8_bf16 v[112:127], v[182:183], v[54:55], v[112:127]
    s_nop 1
    v_mfma_f32_32x32x8_bf16 v[80:95], v[178:179], v[54:55], v[80:95]
    v_lshl_add_u32 v20, v15, 2, s71
    v_rcp_f32 v45, v45
    v_rcp_f32 v47, v47
    ds_write_b32 v20, v45 offset:0
    ds_write_b32 v20, v47 offset:128
    ds_read_b128 v[160:163], v19 offset:0
    ds_read_b128 v[164:167], v19 offset:16
    ds_read_b128 v[168:171], v19 offset:64
    ds_read_b128 v[172:175], v19 offset:80
    ds_read_b128 v[176:179], v19 offset:128
    ds_read_b128 v[180:183], v19 offset:144
    ds_read_b128 v[184:187], v19 offset:192
    ds_read_b128 v[188:191], v19 offset:208
    s_waitcnt lgkmcnt(0)
    v_pk_mul_f32 v[64:65], v[64:65], v[160:161]
    v_pk_mul_f32 v[66:67], v[66:67], v[162:163]
    v_pk_mul_f32 v[68:69], v[68:69], v[164:165]
    v_pk_mul_f32 v[70:71], v[70:71], v[166:167]
    v_pk_mul_f32 v[72:73], v[72:73], v[168:169]
    v_pk_mul_f32 v[74:75], v[74:75], v[170:171]
    v_pk_mul_f32 v[76:77], v[76:77], v[172:173]
    v_pk_mul_f32 v[78:79], v[78:79], v[174:175]
    v_cvt_pk_bf16_f32 v128, v64, v65
    v_cvt_pk_bf16_f32 v129, v66, v67
    v_cvt_pk_bf16_f32 v130, v68, v69
    v_cvt_pk_bf16_f32 v131, v70, v71
    v_cvt_pk_bf16_f32 v132, v72, v73
    v_cvt_pk_bf16_f32 v133, v74, v75
    v_cvt_pk_bf16_f32 v134, v76, v77
    v_cvt_pk_bf16_f32 v135, v78, v79
    v_pk_mul_f32 v[96:97], v[96:97], v[160:161]
    v_pk_mul_f32 v[98:99], v[98:99], v[162:163]
    v_pk_mul_f32 v[100:101], v[100:101], v[164:165]
    v_pk_mul_f32 v[102:103], v[102:103], v[166:167]
    v_pk_mul_f32 v[104:105], v[104:105], v[168:169]
    v_pk_mul_f32 v[106:107], v[106:107], v[170:171]
    v_pk_mul_f32 v[108:109], v[108:109], v[172:173]
    v_pk_mul_f32 v[110:111], v[110:111], v[174:175]
    v_cvt_pk_bf16_f32 v144, v96, v97
    v_cvt_pk_bf16_f32 v145, v98, v99
    v_cvt_pk_bf16_f32 v146, v100, v101
    v_cvt_pk_bf16_f32 v147, v102, v103
    v_cvt_pk_bf16_f32 v148, v104, v105
    v_cvt_pk_bf16_f32 v149, v106, v107
    v_cvt_pk_bf16_f32 v150, v108, v109
    v_cvt_pk_bf16_f32 v151, v110, v111
    v_pk_mul_f32 v[80:81], v[80:81], v[176:177]
    v_pk_mul_f32 v[82:83], v[82:83], v[178:179]
    v_pk_mul_f32 v[84:85], v[84:85], v[180:181]
    v_pk_mul_f32 v[86:87], v[86:87], v[182:183]
    v_pk_mul_f32 v[88:89], v[88:89], v[184:185]
    v_pk_mul_f32 v[90:91], v[90:91], v[186:187]
    v_pk_mul_f32 v[92:93], v[92:93], v[188:189]
    v_pk_mul_f32 v[94:95], v[94:95], v[190:191]
    v_cvt_pk_bf16_f32 v136, v80, v81
    v_cvt_pk_bf16_f32 v137, v82, v83
    v_cvt_pk_bf16_f32 v138, v84, v85
    v_cvt_pk_bf16_f32 v139, v86, v87
    v_cvt_pk_bf16_f32 v140, v88, v89
    v_cvt_pk_bf16_f32 v141, v90, v91
    v_cvt_pk_bf16_f32 v142, v92, v93
    v_cvt_pk_bf16_f32 v143, v94, v95
    v_pk_mul_f32 v[112:113], v[112:113], v[176:177]
    v_pk_mul_f32 v[114:115], v[114:115], v[178:179]
    v_pk_mul_f32 v[116:117], v[116:117], v[180:181]
    v_pk_mul_f32 v[118:119], v[118:119], v[182:183]
    v_pk_mul_f32 v[120:121], v[120:121], v[184:185]
    v_pk_mul_f32 v[122:123], v[122:123], v[186:187]
    v_pk_mul_f32 v[124:125], v[124:125], v[188:189]
    v_pk_mul_f32 v[126:127], v[126:127], v[190:191]
    v_cvt_pk_bf16_f32 v152, v112, v113
    v_cvt_pk_bf16_f32 v153, v114, v115
    v_cvt_pk_bf16_f32 v154, v116, v117
    v_cvt_pk_bf16_f32 v155, v118, v119
    v_cvt_pk_bf16_f32 v156, v120, v121
    v_cvt_pk_bf16_f32 v157, v122, v123
    v_cvt_pk_bf16_f32 v158, v124, v125
    v_cvt_pk_bf16_f32 v159, v126, v127
    v_mfma_f32_32x32x16_bf16 v[64:79], v[128:131], v[224:227], 0
    v_mfma_f32_32x32x16_bf16 v[64:79], v[132:135], v[228:231], v[64:79]
    v_mfma_f32_32x32x16_bf16 v[64:79], v[144:147], v[240:243], v[64:79]
    v_mfma_f32_32x32x16_bf16 v[64:79], v[148:151], v[244:247], v[64:79]
    v_mfma_f32_32x32x16_bf16 v[80:95], v[136:139], v[232:235], 0
    v_mfma_f32_32x32x16_bf16 v[80:95], v[140:143], v[236:239], v[80:95]
    v_mfma_f32_32x32x16_bf16 v[80:95], v[152:155], v[248:251], v[80:95]
    v_mfma_f32_32x32x16_bf16 v[80:95], v[156:159], v[252:255], v[80:95]
    v_mfma_f32_32x32x16_bf16 v[96:111], v[128:131], v[208:211], 0
    v_mfma_f32_32x32x16_bf16 v[96:111], v[132:135], v[212:215], v[96:111]
    v_mfma_f32_32x32x16_bf16 v[96:111], v[144:147], v[192:195], v[96:111]
    v_mfma_f32_32x32x16_bf16 v[96:111], v[148:151], v[196:199], v[96:111]
    v_mfma_f32_32x32x16_bf16 v[112:127], v[136:139], v[216:219], 0
    v_mfma_f32_32x32x16_bf16 v[112:127], v[140:143], v[220:223], v[112:127]
    v_mfma_f32_32x32x16_bf16 v[112:127], v[152:155], v[200:203], v[112:127]
    v_mfma_f32_32x32x16_bf16 v[112:127], v[156:159], v[204:207], v[112:127]
    v_cvt_pk_bf16_f32 v160, v64, v65
    v_cvt_pk_bf16_f32 v161, v66, v67
    v_cvt_pk_bf16_f32 v162, v68, v69
    v_cvt_pk_bf16_f32 v163, v70, v71
    v_cvt_pk_bf16_f32 v164, v72, v73
    v_cvt_pk_bf16_f32 v165, v74, v75
    v_cvt_pk_bf16_f32 v166, v76, v77
    v_cvt_pk_bf16_f32 v167, v78, v79
    ds_write_b128 v48, v[160:163] offset:0
    ds_write_b128 v49, v[164:167] offset:0
    v_cvt_pk_bf16_f32 v168, v80, v81
    v_cvt_pk_bf16_f32 v169, v82, v83
    v_cvt_pk_bf16_f32 v170, v84, v85
    v_cvt_pk_bf16_f32 v171, v86, v87
    v_cvt_pk_bf16_f32 v172, v88, v89
    v_cvt_pk_bf16_f32 v173, v90, v91
    v_cvt_pk_bf16_f32 v174, v92, v93
    v_cvt_pk_bf16_f32 v175, v94, v95
    ds_write_b128 v50, v[168:171] offset:0
    ds_write_b128 v51, v[172:175] offset:0
    ds_read_b128 v[192:195], v16 offset:0
    ds_read_b128 v[196:199], v16 offset:1024
    ds_read_b128 v[200:203], v16 offset:2048
    ds_read_b128 v[204:207], v16 offset:3072
    v_cvt_pk_bf16_f32 v176, v96, v97
    v_cvt_pk_bf16_f32 v177, v98, v99
    v_cvt_pk_bf16_f32 v178, v100, v101
    v_cvt_pk_bf16_f32 v179, v102, v103
    v_cvt_pk_bf16_f32 v180, v104, v105
    v_cvt_pk_bf16_f32 v181, v106, v107
    v_cvt_pk_bf16_f32 v182, v108, v109
    v_cvt_pk_bf16_f32 v183, v110, v111
    ds_write_b128 v48, v[176:179] offset:4096
    ds_write_b128 v49, v[180:183] offset:4096
    v_cvt_pk_bf16_f32 v184, v112, v113
    v_cvt_pk_bf16_f32 v185, v114, v115
    v_cvt_pk_bf16_f32 v186, v116, v117
    v_cvt_pk_bf16_f32 v187, v118, v119
    v_cvt_pk_bf16_f32 v188, v120, v121
    v_cvt_pk_bf16_f32 v189, v122, v123
    v_cvt_pk_bf16_f32 v190, v124, v125
    v_cvt_pk_bf16_f32 v191, v126, v127
    ds_write_b128 v50, v[184:187] offset:4096
    ds_write_b128 v51, v[188:191] offset:4096
    ds_read_b128 v[208:211], v16 offset:4096
    ds_read_b128 v[212:215], v16 offset:5120
    ds_read_b128 v[216:219], v16 offset:6144
    ds_read_b128 v[220:223], v16 offset:7168
    s_waitcnt lgkmcnt(11)
    s_add_u32 s6, s70, 0
    buffer_store_dwordx4 v[192:195], v53, s[56:59], s6 offen sc1
    s_waitcnt lgkmcnt(10)
    s_add_u32 s6, s70, 524288
    buffer_store_dwordx4 v[196:199], v53, s[56:59], s6 offen sc1
    s_waitcnt lgkmcnt(9)
    s_add_u32 s6, s70, 1048576
    buffer_store_dwordx4 v[200:203], v53, s[56:59], s6 offen sc1
    s_waitcnt lgkmcnt(8)
    s_add_u32 s6, s70, 1572864
    buffer_store_dwordx4 v[204:207], v53, s[56:59], s6 offen sc1
    s_waitcnt lgkmcnt(3)
    s_add_u32 s6, s70, 32768
    buffer_store_dwordx4 v[208:211], v53, s[56:59], s6 offen sc1
    s_waitcnt lgkmcnt(2)
    s_add_u32 s6, s70, 557056
    buffer_store_dwordx4 v[212:215], v53, s[56:59], s6 offen sc1
    s_waitcnt lgkmcnt(1)
    s_add_u32 s6, s70, 1081344
    buffer_store_dwordx4 v[216:219], v53, s[56:59], s6 offen sc1
    s_waitcnt lgkmcnt(0)
    s_add_u32 s6, s70, 1605632
    buffer_store_dwordx4 v[220:223], v53, s[56:59], s6 offen sc1
    s_waitcnt vmcnt(0) lgkmcnt(0)
    s_barrier
    s_lshl_b32 s6, s3, 12
    v_mov_b32 v20, 1
    buffer_atomic_add v20, v62, s[64:67], s6 offen offset:128 sc1
L_end:
    s_endpgm
.section .rodata,"a"
.p2align 6
.amdhsa_kernel recurrent_scan__spectral_fnet__geglu_ffn__prompt_kernel
  .amdhsa_next_free_vgpr 256
  .amdhsa_next_free_sgpr 102
  .amdhsa_accum_offset 256
  .amdhsa_group_segment_fixed_size 0
  .amdhsa_kernarg_size 96
  .amdhsa_user_sgpr_count 2
  .amdhsa_user_sgpr_kernarg_segment_ptr 1
  .amdhsa_system_sgpr_workgroup_id_x 1
.end_amdhsa_kernel
```
